```python
import torch

def _softmax(x, axis=-1):
    return torch.softmax(x, dim=axis)

def _gelu(x):
    return torch.nn.functional.gelu(x, approximate='tanh')

def _silu(x):
    return torch.nn.functional.silu(x)

def _sigmoid(x):
    return torch.sigmoid(x)

def _layernorm(x, axis=-1, eps=1e-05):
    m = x.mean(dim=axis, keepdim=True)
    v = x.var(dim=axis, keepdim=True, unbiased=False)
    return (x - m) / torch.sqrt(v + eps)

def _scatter_add(tgt, idx, src, axis=0):
    return tgt.clone().index_add_(axis, idx, src)

def _segment_sum(src, seg, n):
    out = torch.zeros((n,) + src.shape[1:], dtype=src.dtype)
    return out.index_add_(0, seg, src)

def _pad(x, pw):
    flat = tuple((v for pair in reversed(pw) for v in pair))
    return torch.nn.functional.pad(x, flat)
kernel_name = 'gather_scatter__tensor_product_equiv_mace__graph'

def setup_inputs():

    _w = lambda a: (lambda t: t.to(torch.bfloat16) if t.is_floating_point() else t)(torch.as_tensor(a))
    N, deg = (50000, 16)
    Lmax, C, De = (1, 64, 4)
    M = (Lmax + 1) ** 2
    E = N * deg
    src = (lambda lo, hi, *s: torch.randint(lo, hi, s))(0, N, E).to(torch.int64)
    dst = (lambda lo, hi, *s: torch.randint(lo, hi, s))(0, N, E).to(torch.int64)
    r = (lambda *s: torch.randn(*s, dtype=torch.bfloat16) * 0.05)(E, 3).to(float)
    r = r / (torch.linalg.norm(r, dim=-1, keepdim=True).to(float) + 1e-06)
    rx, ry, rz = (r[:, 0].clone(), r[:, 1].clone(), r[:, 2].clone())
    x2, y2, z2 = (rx * rx, ry * ry, rz * rz)
    sh_list = [torch.ones_like(rx), rx, ry, rz, rx * ry, ry * rz, 2.0 * z2 - x2 - y2, rx * rz, x2 - y2, ry * (3.0 * x2 - y2), rx * ry * rz, ry * (4.0 * z2 - x2 - y2), rz * (2.0 * z2 - 3.0 * x2 - 3.0 * y2), rx * (4.0 * z2 - x2 - y2), rz * (x2 - y2), rx * (x2 - 3.0 * y2)]
    sh16 = torch.stack(sh_list, dim=-1).to(float)
    pad = max(0, M - 16)
    sh_full = torch.cat([sh16, torch.zeros((E, pad), dtype=float)], dim=-1)[:, :M]
    cg = ((lambda *s: torch.randn(*s, dtype=torch.bfloat16) * 0.05)(M, M, M) * (1.0 / float(M))).to(float)
    return {'x': _w(((lambda *s: torch.randn(*s, dtype=torch.bfloat16) * 0.05)(N, M, C) * 0.3).to(float)), 'src': _w(src), 'dst': _w(dst), 'sh': _w(sh_full.to(float)), 'edge_attr': _w(((lambda *s: torch.randn(*s, dtype=torch.bfloat16) * 0.05)(E, De) * 0.3).to(float)), 'cg': _w(cg), 'w_r': _w(((lambda *s: torch.randn(*s, dtype=torch.bfloat16) * 0.05)(De, C) * (1.0 / float(De) ** 0.5)).to(float)), 'w_out': _w(((lambda *s: torch.randn(*s, dtype=torch.bfloat16) * 0.05)(C, C) * (1.0 / float(C) ** 0.5)).to(float))}

def reference(x, src, dst, sh, edge_attr, cg, w_r, w_out):
    N = x.shape[0]
    M = x.shape[1]
    C = x.shape[2]
    h = x[src]
    tp = torch.einsum('uvw,euc,ev->ewc', cg, h, sh)
    rw = edge_attr @ w_r
    msg = tp * rw[:, None, :]
    msg2 = msg.reshape(-1, M * C)
    agg = _segment_sum(msg2, dst, N).reshape(N, M, C)
    out = torch.einsum('nmc,cd->nmd', agg, w_out)
    return out
```

```asm
; @launch kernel=k2s_kernel grid=(400,1,1) block=(256,1,1) lds=44288
; @launch kernel=k3b_kernel grid=(196,1,1) block=(1024,1,1) lds=10240
; @launch kernel=k4m_kernel grid=(12500,1,1) block=(256,1,1) lds=2304
.amdgcn_target "amdgcn-amd-amdhsa--gfx950"
.text
.globl k2s_kernel
.p2align 8
.type k2s_kernel,@function
k2s_kernel:
    s_cmp_ge_u32 s2, 400
    s_cbranch_scc1 k2_end
    s_load_dwordx4 s[4:7], s[0:1], 8
    s_load_dwordx4 s[20:23], s[0:1], 24
    s_load_dwordx2 s[24:25], s[0:1], 80
    s_load_dwordx2 s[26:27], s[0:1], 56
    s_waitcnt lgkmcnt(0)
    s_mov_b32 s8, s4
    s_and_b32 s9, s5, 0xffff
    s_mov_b32 s10, 0x30d400
    s_mov_b32 s11, 0x00020000
    s_mov_b32 s12, s6
    s_and_b32 s13, s7, 0xffff
    s_mov_b32 s14, 0x30d400
    s_mov_b32 s15, 0x00020000
    s_mov_b32 s28, s20
    s_and_b32 s29, s21, 0xffff
    s_mov_b32 s30, 0x61a800
    s_mov_b32 s31, 0x00020000
    s_mov_b32 s32, s22
    s_and_b32 s33, s23, 0xffff
    s_mov_b32 s34, 0x61a800
    s_mov_b32 s35, 0x00020000
    s_mov_b32 s36, s24
    s_and_b32 s37, s25, 0xffff
    s_mov_b32 s38, 0x10000000
    s_mov_b32 s39, 0x00020000
    s_mov_b32 s44, s26
    s_and_b32 s45, s27, 0xffff
    s_mov_b32 s46, 0x2000
    s_mov_b32 s47, 0x00020000
    s_cmp_lg_u32 s2, 0
    s_cbranch_scc1 k2_notr
    v_and_b32 v2, 63, v0
    v_lshrrev_b32 v3, 6, v0
    v_lshlrev_b32 v8, 11, v3
    v_lshl_add_u32 v8, v2, 1, v8
    buffer_load_ushort v16, v8, s[44:47], 0 offen offset:0
    buffer_load_ushort v17, v8, s[44:47], 0 offen offset:128
    buffer_load_ushort v18, v8, s[44:47], 0 offen offset:256
    buffer_load_ushort v19, v8, s[44:47], 0 offen offset:384
    buffer_load_ushort v20, v8, s[44:47], 0 offen offset:512
    buffer_load_ushort v21, v8, s[44:47], 0 offen offset:640
    buffer_load_ushort v22, v8, s[44:47], 0 offen offset:768
    buffer_load_ushort v23, v8, s[44:47], 0 offen offset:896
    buffer_load_ushort v24, v8, s[44:47], 0 offen offset:1024
    buffer_load_ushort v25, v8, s[44:47], 0 offen offset:1152
    buffer_load_ushort v26, v8, s[44:47], 0 offen offset:1280
    buffer_load_ushort v27, v8, s[44:47], 0 offen offset:1408
    buffer_load_ushort v28, v8, s[44:47], 0 offen offset:1536
    buffer_load_ushort v29, v8, s[44:47], 0 offen offset:1664
    buffer_load_ushort v30, v8, s[44:47], 0 offen offset:1792
    buffer_load_ushort v31, v8, s[44:47], 0 offen offset:1920
    v_lshlrev_b32 v9, 7, v2
    v_lshl_add_u32 v9, v3, 5, v9
    s_waitcnt vmcnt(0)
    v_lshl_or_b32 v32, v17, 16, v16
    v_lshl_or_b32 v33, v19, 16, v18
    v_lshl_or_b32 v34, v21, 16, v20
    v_lshl_or_b32 v35, v23, 16, v22
    v_lshl_or_b32 v36, v25, 16, v24
    v_lshl_or_b32 v37, v27, 16, v26
    v_lshl_or_b32 v38, v29, 16, v28
    v_lshl_or_b32 v39, v31, 16, v30
    s_mov_b32 s42, 983040
    buffer_store_dwordx4 v[32:35], v9, s[36:39], s42 offen
    buffer_store_dwordx4 v[36:39], v9, s[36:39], s42 offen offset:16
    s_waitcnt vmcnt(0)
k2_notr:
    v_lshlrev_b32 v1, 2, v0
    v_mov_b32 v2, 0
    ds_write_b32 v1, v2 offset:0
    s_mul_i32 s3, s2, 8000
    v_lshlrev_b32 v6, 5, v0
    v_add_u32 v6, s3, v6
    v_lshlrev_b32 v7, 1, v6
    v_cmp_gt_u32 vcc, 250, v0
    s_and_saveexec_b64 s[18:19], vcc
    buffer_load_dwordx4 v[8:11], v6, s[12:15], 0 offen
    buffer_load_dwordx4 v[12:15], v6, s[12:15], 0 offen offset:16
    buffer_load_dwordx4 v[16:19], v6, s[8:11], 0 offen
    buffer_load_dwordx4 v[20:23], v6, s[8:11], 0 offen offset:16
    buffer_load_dwordx4 v[24:27], v7, s[28:31], 0 offen offset:0
    buffer_load_dwordx4 v[28:31], v7, s[28:31], 0 offen offset:16
    buffer_load_dwordx4 v[32:35], v7, s[28:31], 0 offen offset:32
    buffer_load_dwordx4 v[36:39], v7, s[28:31], 0 offen offset:48
    buffer_load_dwordx4 v[40:43], v7, s[32:35], 0 offen offset:0
    buffer_load_dwordx4 v[44:47], v7, s[32:35], 0 offen offset:16
    buffer_load_dwordx4 v[48:51], v7, s[32:35], 0 offen offset:32
    buffer_load_dwordx4 v[52:55], v7, s[32:35], 0 offen offset:48
    s_mov_b64 exec, s[18:19]
    s_waitcnt vmcnt(0) lgkmcnt(0)
    s_barrier
    v_mov_b32 v79, 1
    v_cmp_gt_u32 vcc, 250, v0
    s_and_saveexec_b64 s[16:17], vcc
    v_lshrrev_b32 v68, 8, v8
    v_lshlrev_b32 v68, 2, v68
    v_lshrrev_b32 v69, 8, v9
    v_lshlrev_b32 v69, 2, v69
    v_lshrrev_b32 v70, 8, v10
    v_lshlrev_b32 v70, 2, v70
    v_lshrrev_b32 v71, 8, v11
    v_lshlrev_b32 v71, 2, v71
    v_lshrrev_b32 v72, 8, v12
    v_lshlrev_b32 v72, 2, v72
    v_lshrrev_b32 v73, 8, v13
    v_lshlrev_b32 v73, 2, v73
    v_lshrrev_b32 v74, 8, v14
    v_lshlrev_b32 v74, 2, v74
    v_lshrrev_b32 v75, 8, v15
    v_lshlrev_b32 v75, 2, v75
    ds_add_u32 v68, v79 offset:0
    ds_add_u32 v69, v79 offset:0
    ds_add_u32 v70, v79 offset:0
    ds_add_u32 v71, v79 offset:0
    ds_add_u32 v72, v79 offset:0
    ds_add_u32 v73, v79 offset:0
    ds_add_u32 v74, v79 offset:0
    ds_add_u32 v75, v79 offset:0
    s_mov_b64 exec, s[16:17]
    s_waitcnt lgkmcnt(0)
    s_barrier
    ds_read_b32 v58, v1 offset:0
    s_waitcnt lgkmcnt(0)
    v_mov_b32 v80, v58
    s_nop 1
    v_add_u32_dpp v80, v80, v80 row_shr:1 row_mask:0xf bank_mask:0xf bound_ctrl:0
    s_nop 1
    v_add_u32_dpp v80, v80, v80 row_shr:2 row_mask:0xf bank_mask:0xf bound_ctrl:0
    s_nop 1
    v_add_u32_dpp v80, v80, v80 row_shr:4 row_mask:0xf bank_mask:0xf bound_ctrl:0
    s_nop 1
    v_add_u32_dpp v80, v80, v80 row_shr:8 row_mask:0xf bank_mask:0xf bound_ctrl:0
    s_nop 1
    v_add_u32_dpp v80, v80, v80 row_bcast:15 row_mask:0xa bank_mask:0xf
    s_nop 1
    v_add_u32_dpp v80, v80, v80 row_bcast:31 row_mask:0xc bank_mask:0xf
    s_nop 1
    v_lshrrev_b32 v81, 6, v0
    v_lshlrev_b32 v82, 2, v81
    v_and_b32 v83, 63, v0
    v_cmp_eq_u32 vcc, 63, v83
    s_and_saveexec_b64 s[16:17], vcc
    ds_write_b32 v82, v80 offset:3072
    s_mov_b64 exec, s[16:17]
    s_waitcnt lgkmcnt(0)
    s_barrier
    v_mov_b32 v82, 0
    ds_read_b128 v[84:87], v82 offset:3072
    ds_read_b128 v[88:91], v82 offset:3088
    ds_read_b128 v[92:95], v82 offset:3104
    ds_read_b128 v[96:99], v82 offset:3120
    s_waitcnt lgkmcnt(0)
    v_sub_u32 v58, v80, v58
    v_cmp_lt_u32 vcc, 0, v81
    s_nop 1
    v_cndmask_b32 v84, 0, v84, vcc
    v_add_u32 v58, v58, v84
    v_cmp_lt_u32 vcc, 1, v81
    s_nop 1
    v_cndmask_b32 v85, 0, v85, vcc
    v_add_u32 v58, v58, v85
    v_cmp_lt_u32 vcc, 2, v81
    s_nop 1
    v_cndmask_b32 v86, 0, v86, vcc
    v_add_u32 v58, v58, v86
    v_cmp_lt_u32 vcc, 3, v81
    s_nop 1
    v_cndmask_b32 v87, 0, v87, vcc
    v_add_u32 v58, v58, v87
    s_barrier
    ds_write_b32 v1, v58 offset:1024
    s_movk_i32 s42, 1600
    v_mul_lo_u32 v59, s42, v0
    s_lshl_b32 s42, s2, 2
    s_add_u32 s42, s42, 262144
    buffer_store_dword v58, v59, s[36:39], s42 offen
    s_waitcnt lgkmcnt(0)
    s_barrier
    v_cmp_gt_u32 vcc, 250, v0
    s_and_saveexec_b64 s[16:17], vcc
    ds_add_rtn_u32 v68, v68, v79 offset:1024
    ds_add_rtn_u32 v69, v69, v79 offset:1024
    ds_add_rtn_u32 v70, v70, v79 offset:1024
    ds_add_rtn_u32 v71, v71, v79 offset:1024
    ds_add_rtn_u32 v72, v72, v79 offset:1024
    ds_add_rtn_u32 v73, v73, v79 offset:1024
    ds_add_rtn_u32 v74, v74, v79 offset:1024
    ds_add_rtn_u32 v75, v75, v79 offset:1024
    s_waitcnt lgkmcnt(0)
    v_lshlrev_b32 v8, 16, v8
    v_or_b32 v8, v8, v16
    v_lshlrev_b32 v76, 2, v68
    ds_write_b32 v76, v8 offset:4096
    v_lshlrev_b32 v77, 4, v68
    ds_write_b64 v77, v[24:25] offset:12288
    ds_write_b64 v77, v[40:41] offset:12296
    v_lshlrev_b32 v9, 16, v9
    v_or_b32 v9, v9, v17
    v_lshlrev_b32 v76, 2, v69
    ds_write_b32 v76, v9 offset:4096
    v_lshlrev_b32 v77, 4, v69
    ds_write_b64 v77, v[26:27] offset:12288
    ds_write_b64 v77, v[42:43] offset:12296
    v_lshlrev_b32 v10, 16, v10
    v_or_b32 v10, v10, v18
    v_lshlrev_b32 v76, 2, v70
    ds_write_b32 v76, v10 offset:4096
    v_lshlrev_b32 v77, 4, v70
    ds_write_b64 v77, v[28:29] offset:12288
    ds_write_b64 v77, v[44:45] offset:12296
    v_lshlrev_b32 v11, 16, v11
    v_or_b32 v11, v11, v19
    v_lshlrev_b32 v76, 2, v71
    ds_write_b32 v76, v11 offset:4096
    v_lshlrev_b32 v77, 4, v71
    ds_write_b64 v77, v[30:31] offset:12288
    ds_write_b64 v77, v[46:47] offset:12296
    v_lshlrev_b32 v12, 16, v12
    v_or_b32 v12, v12, v20
    v_lshlrev_b32 v76, 2, v72
    ds_write_b32 v76, v12 offset:4096
    v_lshlrev_b32 v77, 4, v72
    ds_write_b64 v77, v[32:33] offset:12288
    ds_write_b64 v77, v[48:49] offset:12296
    v_lshlrev_b32 v13, 16, v13
    v_or_b32 v13, v13, v21
    v_lshlrev_b32 v76, 2, v73
    ds_write_b32 v76, v13 offset:4096
    v_lshlrev_b32 v77, 4, v73
    ds_write_b64 v77, v[34:35] offset:12288
    ds_write_b64 v77, v[50:51] offset:12296
    v_lshlrev_b32 v14, 16, v14
    v_or_b32 v14, v14, v22
    v_lshlrev_b32 v76, 2, v74
    ds_write_b32 v76, v14 offset:4096
    v_lshlrev_b32 v77, 4, v74
    ds_write_b64 v77, v[36:37] offset:12288
    ds_write_b64 v77, v[52:53] offset:12296
    v_lshlrev_b32 v15, 16, v15
    v_or_b32 v15, v15, v23
    v_lshlrev_b32 v76, 2, v75
    ds_write_b32 v76, v15 offset:4096
    v_lshlrev_b32 v77, 4, v75
    ds_write_b64 v77, v[38:39] offset:12288
    ds_write_b64 v77, v[54:55] offset:12296
    s_mov_b64 exec, s[16:17]
    s_waitcnt lgkmcnt(0)
    s_barrier
    s_add_u32 s40, s3, 1048576
    s_lshl_b32 s41, s3, 2
    s_add_u32 s41, s41, 5242880
    v_lshlrev_b32 v2, 4, v0
    ds_read_b32 v8, v1 offset:4096
    ds_read_b128 v[24:27], v2 offset:12288
    s_waitcnt lgkmcnt(0)
    buffer_store_dword v8, v1, s[36:39], s40 offen offset:0
    v_add_u32 v61, 0, v2
    buffer_store_dwordx4 v[24:27], v61, s[36:39], s41 offen
    ds_read_b32 v9, v1 offset:5120
    ds_read_b128 v[28:31], v2 offset:16384
    s_waitcnt lgkmcnt(0)
    buffer_store_dword v9, v1, s[36:39], s40 offen offset:1024
    v_add_u32 v61, 4096, v2
    buffer_store_dwordx4 v[28:31], v61, s[36:39], s41 offen
    ds_read_b32 v10, v1 offset:6144
    ds_read_b128 v[32:35], v2 offset:20480
    s_waitcnt lgkmcnt(0)
    buffer_store_dword v10, v1, s[36:39], s40 offen offset:2048
    v_add_u32 v61, 8192, v2
    buffer_store_dwordx4 v[32:35], v61, s[36:39], s41 offen
    ds_read_b32 v11, v1 offset:7168
    ds_read_b128 v[36:39], v2 offset:24576
    s_waitcnt lgkmcnt(0)
    buffer_store_dword v11, v1, s[36:39], s40 offen offset:3072
    v_add_u32 v61, 12288, v2
    buffer_store_dwordx4 v[36:39], v61, s[36:39], s41 offen
    ds_read_b32 v12, v1 offset:8192
    ds_read_b128 v[40:43], v2 offset:28672
    s_waitcnt lgkmcnt(0)
    s_nop 0
    v_add_u32 v60, 4096, v1
    buffer_store_dword v12, v60, s[36:39], s40 offen
    v_add_u32 v61, 16384, v2
    buffer_store_dwordx4 v[40:43], v61, s[36:39], s41 offen
    ds_read_b32 v13, v1 offset:9216
    ds_read_b128 v[44:47], v2 offset:32768
    s_waitcnt lgkmcnt(0)
    s_nop 0
    v_add_u32 v60, 5120, v1
    buffer_store_dword v13, v60, s[36:39], s40 offen
    v_add_u32 v61, 20480, v2
    buffer_store_dwordx4 v[44:47], v61, s[36:39], s41 offen
    ds_read_b32 v14, v1 offset:10240
    ds_read_b128 v[48:51], v2 offset:36864
    s_waitcnt lgkmcnt(0)
    s_nop 0
    v_add_u32 v60, 6144, v1
    buffer_store_dword v14, v60, s[36:39], s40 offen
    v_add_u32 v61, 24576, v2
    buffer_store_dwordx4 v[48:51], v61, s[36:39], s41 offen
    v_cmp_gt_u32 vcc, 208, v0
    s_and_saveexec_b64 s[16:17], vcc
    s_cbranch_execz k2_end
    ds_read_b32 v15, v1 offset:11264
    ds_read_b128 v[52:55], v2 offset:40960
    s_waitcnt lgkmcnt(0)
    s_nop 0
    v_add_u32 v60, 7168, v1
    buffer_store_dword v15, v60, s[36:39], s40 offen
    v_add_u32 v61, 28672, v2
    buffer_store_dwordx4 v[52:55], v61, s[36:39], s41 offen
k2_end:
    s_endpgm
.globl k3b_kernel
.p2align 8
.type k3b_kernel,@function
k3b_kernel:
    s_cmp_ge_u32 s2, 196
    s_cbranch_scc1 kb_end
    s_load_dwordx2 s[4:5], s[0:1], 80
    s_waitcnt lgkmcnt(0)
    s_mov_b32 s8, s4
    s_and_b32 s9, s5, 0xffff
    s_mov_b32 s10, 0x10000000
    s_mov_b32 s11, 0x00020000
    v_lshlrev_b32 v1, 2, v0
    v_mov_b32 v2, 0
    ds_write_b32 v1, v2
    v_mov_b32 v3, 1
    v_mov_b32 v10, 0
    v_mov_b32 v11, 0
    s_mul_i32 s20, s2, 1600
    s_add_u32 s20, s20, 262144
    s_add_u32 s21, s20, 1600
    v_cmp_gt_u32 vcc, 400, v0
    s_and_saveexec_b64 s[18:19], vcc
    s_cbranch_execz kb_nh
    buffer_load_dword v10, v1, s[8:11], s20 offen
    buffer_load_dword v11, v1, s[8:11], s21 offen
    s_waitcnt vmcnt(0)
kb_nh:
    s_mov_b64 exec, s[18:19]
    v_sub_u32 v11, v11, v10
    v_mov_b32 v12, v10
    v_mov_b32 v20, v12
    s_nop 1
    v_add_u32_dpp v20, v20, v20 row_shr:1 row_mask:0xf bank_mask:0xf bound_ctrl:0
    s_nop 1
    v_add_u32_dpp v20, v20, v20 row_shr:2 row_mask:0xf bank_mask:0xf bound_ctrl:0
    s_nop 1
    v_add_u32_dpp v20, v20, v20 row_shr:4 row_mask:0xf bank_mask:0xf bound_ctrl:0
    s_nop 1
    v_add_u32_dpp v20, v20, v20 row_shr:8 row_mask:0xf bank_mask:0xf bound_ctrl:0
    s_nop 1
    v_add_u32_dpp v20, v20, v20 row_bcast:15 row_mask:0xa bank_mask:0xf
    s_nop 1
    v_add_u32_dpp v20, v20, v20 row_bcast:31 row_mask:0xc bank_mask:0xf
    s_nop 1
    v_lshrrev_b32 v21, 6, v0
    v_lshlrev_b32 v22, 2, v21
    v_and_b32 v23, 63, v0
    v_cmp_eq_u32 vcc, 63, v23
    s_and_saveexec_b64 s[16:17], vcc
    ds_write_b32 v22, v20 offset:5120
    s_mov_b64 exec, s[16:17]
    s_waitcnt lgkmcnt(0)
    s_barrier
    v_mov_b32 v22, 0
    ds_read_b128 v[24:27], v22 offset:5120
    ds_read_b128 v[28:31], v22 offset:5136
    ds_read_b128 v[32:35], v22 offset:5152
    ds_read_b128 v[36:39], v22 offset:5168
    s_waitcnt lgkmcnt(0)
    v_sub_u32 v12, v20, v12
    v_mov_b32 v13, 0
    v_add_u32 v13, v13, v24
    v_cmp_lt_u32 vcc, 0, v21
    s_nop 1
    v_cndmask_b32 v24, 0, v24, vcc
    v_add_u32 v12, v12, v24
    v_add_u32 v13, v13, v25
    v_cmp_lt_u32 vcc, 1, v21
    s_nop 1
    v_cndmask_b32 v25, 0, v25, vcc
    v_add_u32 v12, v12, v25
    v_add_u32 v13, v13, v26
    v_cmp_lt_u32 vcc, 2, v21
    s_nop 1
    v_cndmask_b32 v26, 0, v26, vcc
    v_add_u32 v12, v12, v26
    v_add_u32 v13, v13, v27
    v_cmp_lt_u32 vcc, 3, v21
    s_nop 1
    v_cndmask_b32 v27, 0, v27, vcc
    v_add_u32 v12, v12, v27
    v_add_u32 v13, v13, v28
    v_cmp_lt_u32 vcc, 4, v21
    s_nop 1
    v_cndmask_b32 v28, 0, v28, vcc
    v_add_u32 v12, v12, v28
    v_add_u32 v13, v13, v29
    v_cmp_lt_u32 vcc, 5, v21
    s_nop 1
    v_cndmask_b32 v29, 0, v29, vcc
    v_add_u32 v12, v12, v29
    v_add_u32 v13, v13, v30
    v_cmp_lt_u32 vcc, 6, v21
    s_nop 1
    v_cndmask_b32 v30, 0, v30, vcc
    v_add_u32 v12, v12, v30
    v_add_u32 v13, v13, v31
    v_cmp_lt_u32 vcc, 7, v21
    s_nop 1
    v_cndmask_b32 v31, 0, v31, vcc
    v_add_u32 v12, v12, v31
    v_add_u32 v13, v13, v32
    v_cmp_lt_u32 vcc, 8, v21
    s_nop 1
    v_cndmask_b32 v32, 0, v32, vcc
    v_add_u32 v12, v12, v32
    v_add_u32 v13, v13, v33
    v_cmp_lt_u32 vcc, 9, v21
    s_nop 1
    v_cndmask_b32 v33, 0, v33, vcc
    v_add_u32 v12, v12, v33
    v_add_u32 v13, v13, v34
    v_cmp_lt_u32 vcc, 10, v21
    s_nop 1
    v_cndmask_b32 v34, 0, v34, vcc
    v_add_u32 v12, v12, v34
    v_add_u32 v13, v13, v35
    v_cmp_lt_u32 vcc, 11, v21
    s_nop 1
    v_cndmask_b32 v35, 0, v35, vcc
    v_add_u32 v12, v12, v35
    v_add_u32 v13, v13, v36
    v_cmp_lt_u32 vcc, 12, v21
    s_nop 1
    v_cndmask_b32 v36, 0, v36, vcc
    v_add_u32 v12, v12, v36
    v_add_u32 v13, v13, v37
    v_cmp_lt_u32 vcc, 13, v21
    s_nop 1
    v_cndmask_b32 v37, 0, v37, vcc
    v_add_u32 v12, v12, v37
    v_add_u32 v13, v13, v38
    v_cmp_lt_u32 vcc, 14, v21
    s_nop 1
    v_cndmask_b32 v38, 0, v38, vcc
    v_add_u32 v12, v12, v38
    v_add_u32 v13, v13, v39
    v_cmp_lt_u32 vcc, 15, v21
    s_nop 1
    v_cndmask_b32 v39, 0, v39, vcc
    v_add_u32 v12, v12, v39
    s_barrier
    v_mov_b32 v20, v11
    s_nop 1
    v_add_u32_dpp v20, v20, v20 row_shr:1 row_mask:0xf bank_mask:0xf bound_ctrl:0
    s_nop 1
    v_add_u32_dpp v20, v20, v20 row_shr:2 row_mask:0xf bank_mask:0xf bound_ctrl:0
    s_nop 1
    v_add_u32_dpp v20, v20, v20 row_shr:4 row_mask:0xf bank_mask:0xf bound_ctrl:0
    s_nop 1
    v_add_u32_dpp v20, v20, v20 row_shr:8 row_mask:0xf bank_mask:0xf bound_ctrl:0
    s_nop 1
    v_add_u32_dpp v20, v20, v20 row_bcast:15 row_mask:0xa bank_mask:0xf
    s_nop 1
    v_add_u32_dpp v20, v20, v20 row_bcast:31 row_mask:0xc bank_mask:0xf
    s_nop 1
    v_lshrrev_b32 v21, 6, v0
    v_lshlrev_b32 v22, 2, v21
    v_and_b32 v23, 63, v0
    v_cmp_eq_u32 vcc, 63, v23
    s_and_saveexec_b64 s[16:17], vcc
    ds_write_b32 v22, v20 offset:5120
    s_mov_b64 exec, s[16:17]
    s_waitcnt lgkmcnt(0)
    s_barrier
    v_mov_b32 v22, 0
    ds_read_b128 v[24:27], v22 offset:5120
    ds_read_b128 v[28:31], v22 offset:5136
    ds_read_b128 v[32:35], v22 offset:5152
    ds_read_b128 v[36:39], v22 offset:5168
    s_waitcnt lgkmcnt(0)
    v_sub_u32 v11, v20, v11
    v_mov_b32 v14, 0
    v_add_u32 v14, v14, v24
    v_cmp_lt_u32 vcc, 0, v21
    s_nop 1
    v_cndmask_b32 v24, 0, v24, vcc
    v_add_u32 v11, v11, v24
    v_add_u32 v14, v14, v25
    v_cmp_lt_u32 vcc, 1, v21
    s_nop 1
    v_cndmask_b32 v25, 0, v25, vcc
    v_add_u32 v11, v11, v25
    v_add_u32 v14, v14, v26
    v_cmp_lt_u32 vcc, 2, v21
    s_nop 1
    v_cndmask_b32 v26, 0, v26, vcc
    v_add_u32 v11, v11, v26
    v_add_u32 v14, v14, v27
    v_cmp_lt_u32 vcc, 3, v21
    s_nop 1
    v_cndmask_b32 v27, 0, v27, vcc
    v_add_u32 v11, v11, v27
    v_add_u32 v14, v14, v28
    v_cmp_lt_u32 vcc, 4, v21
    s_nop 1
    v_cndmask_b32 v28, 0, v28, vcc
    v_add_u32 v11, v11, v28
    v_add_u32 v14, v14, v29
    v_cmp_lt_u32 vcc, 5, v21
    s_nop 1
    v_cndmask_b32 v29, 0, v29, vcc
    v_add_u32 v11, v11, v29
    v_add_u32 v14, v14, v30
    v_cmp_lt_u32 vcc, 6, v21
    s_nop 1
    v_cndmask_b32 v30, 0, v30, vcc
    v_add_u32 v11, v11, v30
    v_add_u32 v14, v14, v31
    v_cmp_lt_u32 vcc, 7, v21
    s_nop 1
    v_cndmask_b32 v31, 0, v31, vcc
    v_add_u32 v11, v11, v31
    v_add_u32 v14, v14, v32
    v_cmp_lt_u32 vcc, 8, v21
    s_nop 1
    v_cndmask_b32 v32, 0, v32, vcc
    v_add_u32 v11, v11, v32
    v_add_u32 v14, v14, v33
    v_cmp_lt_u32 vcc, 9, v21
    s_nop 1
    v_cndmask_b32 v33, 0, v33, vcc
    v_add_u32 v11, v11, v33
    v_add_u32 v14, v14, v34
    v_cmp_lt_u32 vcc, 10, v21
    s_nop 1
    v_cndmask_b32 v34, 0, v34, vcc
    v_add_u32 v11, v11, v34
    v_add_u32 v14, v14, v35
    v_cmp_lt_u32 vcc, 11, v21
    s_nop 1
    v_cndmask_b32 v35, 0, v35, vcc
    v_add_u32 v11, v11, v35
    v_add_u32 v14, v14, v36
    v_cmp_lt_u32 vcc, 12, v21
    s_nop 1
    v_cndmask_b32 v36, 0, v36, vcc
    v_add_u32 v11, v11, v36
    v_add_u32 v14, v14, v37
    v_cmp_lt_u32 vcc, 13, v21
    s_nop 1
    v_cndmask_b32 v37, 0, v37, vcc
    v_add_u32 v11, v11, v37
    v_add_u32 v14, v14, v38
    v_cmp_lt_u32 vcc, 14, v21
    s_nop 1
    v_cndmask_b32 v38, 0, v38, vcc
    v_add_u32 v11, v11, v38
    v_add_u32 v14, v14, v39
    v_cmp_lt_u32 vcc, 15, v21
    s_nop 1
    v_cndmask_b32 v39, 0, v39, vcc
    v_add_u32 v11, v11, v39
    s_barrier
    v_mul_u32_u24 v15, 2000, v0
    v_add_u32 v15, v15, v10
    v_sub_u32 v15, v15, v11
    v_cmp_gt_u32 vcc, 400, v0
    s_nop 1
    v_cndmask_b32 v11, -1, v11, vcc
    v_cmp_gt_u32 vcc, 512, v0
    s_and_saveexec_b64 s[18:19], vcc
    ds_write_b32 v1, v11 offset:6144
    ds_write_b32 v1, v15 offset:8192
    s_mov_b64 exec, s[18:19]
    v_readfirstlane_b32 s12, v13
    v_readfirstlane_b32 s13, v14
    s_mov_b32 s20, 1048576
    s_waitcnt lgkmcnt(0)
    s_barrier
    v_mov_b32 v4, v0
    s_sub_u32 s24, s13, 1
kb_l1:
    v_cmp_gt_u32 vcc, s13, v4
    s_and_saveexec_b64 s[16:17], vcc
    s_cbranch_execz kb_l1e
    v_add_u32 v60, 0, v4
    v_min_u32 v44, s24, v60
    v_add_u32 v61, 1024, v4
    v_min_u32 v45, s24, v61
    v_add_u32 v62, 2048, v4
    v_min_u32 v46, s24, v62
    v_add_u32 v63, 3072, v4
    v_min_u32 v47, s24, v63
    v_mov_b32 v48, 0
    v_mov_b32 v49, 0
    v_mov_b32 v50, 0
    v_mov_b32 v51, 0
    v_add_u32 v52, 256, v48
    v_lshlrev_b32 v52, 2, v52
    ds_read_b32 v56, v52 offset:6144
    v_add_u32 v53, 256, v49
    v_lshlrev_b32 v53, 2, v53
    ds_read_b32 v57, v53 offset:6144
    v_add_u32 v54, 256, v50
    v_lshlrev_b32 v54, 2, v54
    ds_read_b32 v58, v54 offset:6144
    v_add_u32 v55, 256, v51
    v_lshlrev_b32 v55, 2, v55
    ds_read_b32 v59, v55 offset:6144
    s_waitcnt lgkmcnt(0)
    v_lshrrev_b32 v52, 2, v52
    v_cmp_le_u32 vcc, v56, v44
    s_nop 1
    v_cndmask_b32 v48, v48, v52, vcc
    v_lshrrev_b32 v53, 2, v53
    v_cmp_le_u32 vcc, v57, v45
    s_nop 1
    v_cndmask_b32 v49, v49, v53, vcc
    v_lshrrev_b32 v54, 2, v54
    v_cmp_le_u32 vcc, v58, v46
    s_nop 1
    v_cndmask_b32 v50, v50, v54, vcc
    v_lshrrev_b32 v55, 2, v55
    v_cmp_le_u32 vcc, v59, v47
    s_nop 1
    v_cndmask_b32 v51, v51, v55, vcc
    v_add_u32 v52, 128, v48
    v_lshlrev_b32 v52, 2, v52
    ds_read_b32 v56, v52 offset:6144
    v_add_u32 v53, 128, v49
    v_lshlrev_b32 v53, 2, v53
    ds_read_b32 v57, v53 offset:6144
    v_add_u32 v54, 128, v50
    v_lshlrev_b32 v54, 2, v54
    ds_read_b32 v58, v54 offset:6144
    v_add_u32 v55, 128, v51
    v_lshlrev_b32 v55, 2, v55
    ds_read_b32 v59, v55 offset:6144
    s_waitcnt lgkmcnt(0)
    v_lshrrev_b32 v52, 2, v52
    v_cmp_le_u32 vcc, v56, v44
    s_nop 1
    v_cndmask_b32 v48, v48, v52, vcc
    v_lshrrev_b32 v53, 2, v53
    v_cmp_le_u32 vcc, v57, v45
    s_nop 1
    v_cndmask_b32 v49, v49, v53, vcc
    v_lshrrev_b32 v54, 2, v54
    v_cmp_le_u32 vcc, v58, v46
    s_nop 1
    v_cndmask_b32 v50, v50, v54, vcc
    v_lshrrev_b32 v55, 2, v55
    v_cmp_le_u32 vcc, v59, v47
    s_nop 1
    v_cndmask_b32 v51, v51, v55, vcc
    v_add_lshl_u32 v52, v48, 64, 2
    ds_read_b32 v56, v52 offset:6144
    v_add_lshl_u32 v53, v49, 64, 2
    ds_read_b32 v57, v53 offset:6144
    v_add_lshl_u32 v54, v50, 64, 2
    ds_read_b32 v58, v54 offset:6144
    v_add_lshl_u32 v55, v51, 64, 2
    ds_read_b32 v59, v55 offset:6144
    s_waitcnt lgkmcnt(0)
    v_lshrrev_b32 v52, 2, v52
    v_cmp_le_u32 vcc, v56, v44
    s_nop 1
    v_cndmask_b32 v48, v48, v52, vcc
    v_lshrrev_b32 v53, 2, v53
    v_cmp_le_u32 vcc, v57, v45
    s_nop 1
    v_cndmask_b32 v49, v49, v53, vcc
    v_lshrrev_b32 v54, 2, v54
    v_cmp_le_u32 vcc, v58, v46
    s_nop 1
    v_cndmask_b32 v50, v50, v54, vcc
    v_lshrrev_b32 v55, 2, v55
    v_cmp_le_u32 vcc, v59, v47
    s_nop 1
    v_cndmask_b32 v51, v51, v55, vcc
    v_add_lshl_u32 v52, v48, 32, 2
    ds_read_b32 v56, v52 offset:6144
    v_add_lshl_u32 v53, v49, 32, 2
    ds_read_b32 v57, v53 offset:6144
    v_add_lshl_u32 v54, v50, 32, 2
    ds_read_b32 v58, v54 offset:6144
    v_add_lshl_u32 v55, v51, 32, 2
    ds_read_b32 v59, v55 offset:6144
    s_waitcnt lgkmcnt(0)
    v_lshrrev_b32 v52, 2, v52
    v_cmp_le_u32 vcc, v56, v44
    s_nop 1
    v_cndmask_b32 v48, v48, v52, vcc
    v_lshrrev_b32 v53, 2, v53
    v_cmp_le_u32 vcc, v57, v45
    s_nop 1
    v_cndmask_b32 v49, v49, v53, vcc
    v_lshrrev_b32 v54, 2, v54
    v_cmp_le_u32 vcc, v58, v46
    s_nop 1
    v_cndmask_b32 v50, v50, v54, vcc
    v_lshrrev_b32 v55, 2, v55
    v_cmp_le_u32 vcc, v59, v47
    s_nop 1
    v_cndmask_b32 v51, v51, v55, vcc
    v_add_lshl_u32 v52, v48, 16, 2
    ds_read_b32 v56, v52 offset:6144
    v_add_lshl_u32 v53, v49, 16, 2
    ds_read_b32 v57, v53 offset:6144
    v_add_lshl_u32 v54, v50, 16, 2
    ds_read_b32 v58, v54 offset:6144
    v_add_lshl_u32 v55, v51, 16, 2
    ds_read_b32 v59, v55 offset:6144
    s_waitcnt lgkmcnt(0)
    v_lshrrev_b32 v52, 2, v52
    v_cmp_le_u32 vcc, v56, v44
    s_nop 1
    v_cndmask_b32 v48, v48, v52, vcc
    v_lshrrev_b32 v53, 2, v53
    v_cmp_le_u32 vcc, v57, v45
    s_nop 1
    v_cndmask_b32 v49, v49, v53, vcc
    v_lshrrev_b32 v54, 2, v54
    v_cmp_le_u32 vcc, v58, v46
    s_nop 1
    v_cndmask_b32 v50, v50, v54, vcc
    v_lshrrev_b32 v55, 2, v55
    v_cmp_le_u32 vcc, v59, v47
    s_nop 1
    v_cndmask_b32 v51, v51, v55, vcc
    v_add_lshl_u32 v52, v48, 8, 2
    ds_read_b32 v56, v52 offset:6144
    v_add_lshl_u32 v53, v49, 8, 2
    ds_read_b32 v57, v53 offset:6144
    v_add_lshl_u32 v54, v50, 8, 2
    ds_read_b32 v58, v54 offset:6144
    v_add_lshl_u32 v55, v51, 8, 2
    ds_read_b32 v59, v55 offset:6144
    s_waitcnt lgkmcnt(0)
    v_lshrrev_b32 v52, 2, v52
    v_cmp_le_u32 vcc, v56, v44
    s_nop 1
    v_cndmask_b32 v48, v48, v52, vcc
    v_lshrrev_b32 v53, 2, v53
    v_cmp_le_u32 vcc, v57, v45
    s_nop 1
    v_cndmask_b32 v49, v49, v53, vcc
    v_lshrrev_b32 v54, 2, v54
    v_cmp_le_u32 vcc, v58, v46
    s_nop 1
    v_cndmask_b32 v50, v50, v54, vcc
    v_lshrrev_b32 v55, 2, v55
    v_cmp_le_u32 vcc, v59, v47
    s_nop 1
    v_cndmask_b32 v51, v51, v55, vcc
    v_add_lshl_u32 v52, v48, 4, 2
    ds_read_b32 v56, v52 offset:6144
    v_add_lshl_u32 v53, v49, 4, 2
    ds_read_b32 v57, v53 offset:6144
    v_add_lshl_u32 v54, v50, 4, 2
    ds_read_b32 v58, v54 offset:6144
    v_add_lshl_u32 v55, v51, 4, 2
    ds_read_b32 v59, v55 offset:6144
    s_waitcnt lgkmcnt(0)
    v_lshrrev_b32 v52, 2, v52
    v_cmp_le_u32 vcc, v56, v44
    s_nop 1
    v_cndmask_b32 v48, v48, v52, vcc
    v_lshrrev_b32 v53, 2, v53
    v_cmp_le_u32 vcc, v57, v45
    s_nop 1
    v_cndmask_b32 v49, v49, v53, vcc
    v_lshrrev_b32 v54, 2, v54
    v_cmp_le_u32 vcc, v58, v46
    s_nop 1
    v_cndmask_b32 v50, v50, v54, vcc
    v_lshrrev_b32 v55, 2, v55
    v_cmp_le_u32 vcc, v59, v47
    s_nop 1
    v_cndmask_b32 v51, v51, v55, vcc
    v_add_lshl_u32 v52, v48, 2, 2
    ds_read_b32 v56, v52 offset:6144
    v_add_lshl_u32 v53, v49, 2, 2
    ds_read_b32 v57, v53 offset:6144
    v_add_lshl_u32 v54, v50, 2, 2
    ds_read_b32 v58, v54 offset:6144
    v_add_lshl_u32 v55, v51, 2, 2
    ds_read_b32 v59, v55 offset:6144
    s_waitcnt lgkmcnt(0)
    v_lshrrev_b32 v52, 2, v52
    v_cmp_le_u32 vcc, v56, v44
    s_nop 1
    v_cndmask_b32 v48, v48, v52, vcc
    v_lshrrev_b32 v53, 2, v53
    v_cmp_le_u32 vcc, v57, v45
    s_nop 1
    v_cndmask_b32 v49, v49, v53, vcc
    v_lshrrev_b32 v54, 2, v54
    v_cmp_le_u32 vcc, v58, v46
    s_nop 1
    v_cndmask_b32 v50, v50, v54, vcc
    v_lshrrev_b32 v55, 2, v55
    v_cmp_le_u32 vcc, v59, v47
    s_nop 1
    v_cndmask_b32 v51, v51, v55, vcc
    v_add_lshl_u32 v52, v48, 1, 2
    ds_read_b32 v56, v52 offset:6144
    v_add_lshl_u32 v53, v49, 1, 2
    ds_read_b32 v57, v53 offset:6144
    v_add_lshl_u32 v54, v50, 1, 2
    ds_read_b32 v58, v54 offset:6144
    v_add_lshl_u32 v55, v51, 1, 2
    ds_read_b32 v59, v55 offset:6144
    s_waitcnt lgkmcnt(0)
    v_lshrrev_b32 v52, 2, v52
    v_cmp_le_u32 vcc, v56, v44
    s_nop 1
    v_cndmask_b32 v48, v48, v52, vcc
    v_lshrrev_b32 v53, 2, v53
    v_cmp_le_u32 vcc, v57, v45
    s_nop 1
    v_cndmask_b32 v49, v49, v53, vcc
    v_lshrrev_b32 v54, 2, v54
    v_cmp_le_u32 vcc, v58, v46
    s_nop 1
    v_cndmask_b32 v50, v50, v54, vcc
    v_lshrrev_b32 v55, 2, v55
    v_cmp_le_u32 vcc, v59, v47
    s_nop 1
    v_cndmask_b32 v51, v51, v55, vcc
    v_lshlrev_b32 v48, 2, v48
    ds_read_b32 v48, v48 offset:8192
    v_lshlrev_b32 v49, 2, v49
    ds_read_b32 v49, v49 offset:8192
    v_lshlrev_b32 v50, 2, v50
    ds_read_b32 v50, v50 offset:8192
    v_lshlrev_b32 v51, 2, v51
    ds_read_b32 v51, v51 offset:8192
    s_waitcnt lgkmcnt(0)
    v_add_u32 v48, v48, v44
    v_add_u32 v49, v49, v45
    v_add_u32 v50, v50, v46
    v_add_u32 v51, v51, v47
    v_lshlrev_b32 v52, 2, v48
    buffer_load_dword v56, v52, s[8:11], s20 offen
    v_lshlrev_b32 v53, 2, v49
    buffer_load_dword v57, v53, s[8:11], s20 offen
    v_lshlrev_b32 v54, 2, v50
    buffer_load_dword v58, v54, s[8:11], s20 offen
    v_lshlrev_b32 v55, 2, v51
    buffer_load_dword v59, v55, s[8:11], s20 offen
    s_waitcnt vmcnt(0)
    v_bfe_u32 v56, v56, 16, 8
    v_lshlrev_b32 v56, 2, v56
    v_cmp_gt_u32 vcc, s13, v60
    s_and_saveexec_b64 s[14:15], vcc
    ds_add_u32 v56, v3
    s_mov_b64 exec, s[14:15]
    v_bfe_u32 v57, v57, 16, 8
    v_lshlrev_b32 v57, 2, v57
    v_cmp_gt_u32 vcc, s13, v61
    s_and_saveexec_b64 s[14:15], vcc
    ds_add_u32 v57, v3
    s_mov_b64 exec, s[14:15]
    v_bfe_u32 v58, v58, 16, 8
    v_lshlrev_b32 v58, 2, v58
    v_cmp_gt_u32 vcc, s13, v62
    s_and_saveexec_b64 s[14:15], vcc
    ds_add_u32 v58, v3
    s_mov_b64 exec, s[14:15]
    v_bfe_u32 v59, v59, 16, 8
    v_lshlrev_b32 v59, 2, v59
    v_cmp_gt_u32 vcc, s13, v63
    s_and_saveexec_b64 s[14:15], vcc
    ds_add_u32 v59, v3
    s_mov_b64 exec, s[14:15]
    v_add_u32 v4, 4096, v4
    s_branch kb_l1
kb_l1e:
    s_mov_b64 exec, -1
    s_waitcnt lgkmcnt(0)
    s_barrier
    ds_read_b32 v8, v1
    s_waitcnt lgkmcnt(0)
    v_mov_b32 v20, v8
    s_nop 1
    v_add_u32_dpp v20, v20, v20 row_shr:1 row_mask:0xf bank_mask:0xf bound_ctrl:0
    s_nop 1
    v_add_u32_dpp v20, v20, v20 row_shr:2 row_mask:0xf bank_mask:0xf bound_ctrl:0
    s_nop 1
    v_add_u32_dpp v20, v20, v20 row_shr:4 row_mask:0xf bank_mask:0xf bound_ctrl:0
    s_nop 1
    v_add_u32_dpp v20, v20, v20 row_shr:8 row_mask:0xf bank_mask:0xf bound_ctrl:0
    s_nop 1
    v_add_u32_dpp v20, v20, v20 row_bcast:15 row_mask:0xa bank_mask:0xf
    s_nop 1
    v_add_u32_dpp v20, v20, v20 row_bcast:31 row_mask:0xc bank_mask:0xf
    s_nop 1
    v_lshrrev_b32 v21, 6, v0
    v_lshlrev_b32 v22, 2, v21
    v_and_b32 v23, 63, v0
    v_cmp_eq_u32 vcc, 63, v23
    s_and_saveexec_b64 s[16:17], vcc
    ds_write_b32 v22, v20 offset:5120
    s_mov_b64 exec, s[16:17]
    s_waitcnt lgkmcnt(0)
    s_barrier
    v_mov_b32 v22, 0
    ds_read_b128 v[24:27], v22 offset:5120
    ds_read_b128 v[28:31], v22 offset:5136
    ds_read_b128 v[32:35], v22 offset:5152
    ds_read_b128 v[36:39], v22 offset:5168
    s_waitcnt lgkmcnt(0)
    v_sub_u32 v8, v20, v8
    v_cmp_lt_u32 vcc, 0, v21
    s_nop 1
    v_cndmask_b32 v24, 0, v24, vcc
    v_add_u32 v8, v8, v24
    v_cmp_lt_u32 vcc, 1, v21
    s_nop 1
    v_cndmask_b32 v25, 0, v25, vcc
    v_add_u32 v8, v8, v25
    v_cmp_lt_u32 vcc, 2, v21
    s_nop 1
    v_cndmask_b32 v26, 0, v26, vcc
    v_add_u32 v8, v8, v26
    v_cmp_lt_u32 vcc, 3, v21
    s_nop 1
    v_cndmask_b32 v27, 0, v27, vcc
    v_add_u32 v8, v8, v27
    v_cmp_lt_u32 vcc, 4, v21
    s_nop 1
    v_cndmask_b32 v28, 0, v28, vcc
    v_add_u32 v8, v8, v28
    v_cmp_lt_u32 vcc, 5, v21
    s_nop 1
    v_cndmask_b32 v29, 0, v29, vcc
    v_add_u32 v8, v8, v29
    v_cmp_lt_u32 vcc, 6, v21
    s_nop 1
    v_cndmask_b32 v30, 0, v30, vcc
    v_add_u32 v8, v8, v30
    v_cmp_lt_u32 vcc, 7, v21
    s_nop 1
    v_cndmask_b32 v31, 0, v31, vcc
    v_add_u32 v8, v8, v31
    v_cmp_lt_u32 vcc, 8, v21
    s_nop 1
    v_cndmask_b32 v32, 0, v32, vcc
    v_add_u32 v8, v8, v32
    v_cmp_lt_u32 vcc, 9, v21
    s_nop 1
    v_cndmask_b32 v33, 0, v33, vcc
    v_add_u32 v8, v8, v33
    v_cmp_lt_u32 vcc, 10, v21
    s_nop 1
    v_cndmask_b32 v34, 0, v34, vcc
    v_add_u32 v8, v8, v34
    v_cmp_lt_u32 vcc, 11, v21
    s_nop 1
    v_cndmask_b32 v35, 0, v35, vcc
    v_add_u32 v8, v8, v35
    v_cmp_lt_u32 vcc, 12, v21
    s_nop 1
    v_cndmask_b32 v36, 0, v36, vcc
    v_add_u32 v8, v8, v36
    v_cmp_lt_u32 vcc, 13, v21
    s_nop 1
    v_cndmask_b32 v37, 0, v37, vcc
    v_add_u32 v8, v8, v37
    v_cmp_lt_u32 vcc, 14, v21
    s_nop 1
    v_cndmask_b32 v38, 0, v38, vcc
    v_add_u32 v8, v8, v38
    v_cmp_lt_u32 vcc, 15, v21
    s_nop 1
    v_cndmask_b32 v39, 0, v39, vcc
    v_add_u32 v8, v8, v39
    s_barrier
    v_add_u32 v8, s12, v8
    v_cmp_gt_u32 vcc, 256, v0
    s_and_saveexec_b64 s[16:17], vcc
    s_cbranch_execz kb_sk
    ds_write_b32 v1, v8 offset:4096
    s_lshl_b32 s21, s2, 8
    v_add_u32 v9, s21, v0
    v_cmp_ge_u32 vcc, 50000, v9
    s_and_b64 exec, exec, vcc
    s_cbranch_execz kb_sk
    v_lshlrev_b32 v9, 2, v9
    s_mov_b32 s20, 16384
    buffer_store_dword v8, v9, s[8:11], s20 offen
kb_sk:
    s_mov_b64 exec, -1
    s_waitcnt lgkmcnt(0)
    s_barrier
    v_mov_b32 v4, v0
    s_mov_b32 s20, 1048576
    s_mov_b32 s21, 5242880
    s_mov_b32 s22, 18874368
    s_mov_b32 s23, 23068672
kb_l2:
    v_cmp_gt_u32 vcc, s13, v4
    s_and_saveexec_b64 s[16:17], vcc
    s_cbranch_execz kb_end
    v_add_u32 v60, 0, v4
    v_min_u32 v44, s24, v60
    v_add_u32 v61, 1024, v4
    v_min_u32 v45, s24, v61
    v_add_u32 v62, 2048, v4
    v_min_u32 v46, s24, v62
    v_add_u32 v63, 3072, v4
    v_min_u32 v47, s24, v63
    v_mov_b32 v48, 0
    v_mov_b32 v49, 0
    v_mov_b32 v50, 0
    v_mov_b32 v51, 0
    v_add_u32 v52, 256, v48
    v_lshlrev_b32 v52, 2, v52
    ds_read_b32 v56, v52 offset:6144
    v_add_u32 v53, 256, v49
    v_lshlrev_b32 v53, 2, v53
    ds_read_b32 v57, v53 offset:6144
    v_add_u32 v54, 256, v50
    v_lshlrev_b32 v54, 2, v54
    ds_read_b32 v58, v54 offset:6144
    v_add_u32 v55, 256, v51
    v_lshlrev_b32 v55, 2, v55
    ds_read_b32 v59, v55 offset:6144
    s_waitcnt lgkmcnt(0)
    v_lshrrev_b32 v52, 2, v52
    v_cmp_le_u32 vcc, v56, v44
    s_nop 1
    v_cndmask_b32 v48, v48, v52, vcc
    v_lshrrev_b32 v53, 2, v53
    v_cmp_le_u32 vcc, v57, v45
    s_nop 1
    v_cndmask_b32 v49, v49, v53, vcc
    v_lshrrev_b32 v54, 2, v54
    v_cmp_le_u32 vcc, v58, v46
    s_nop 1
    v_cndmask_b32 v50, v50, v54, vcc
    v_lshrrev_b32 v55, 2, v55
    v_cmp_le_u32 vcc, v59, v47
    s_nop 1
    v_cndmask_b32 v51, v51, v55, vcc
    v_add_u32 v52, 128, v48
    v_lshlrev_b32 v52, 2, v52
    ds_read_b32 v56, v52 offset:6144
    v_add_u32 v53, 128, v49
    v_lshlrev_b32 v53, 2, v53
    ds_read_b32 v57, v53 offset:6144
    v_add_u32 v54, 128, v50
    v_lshlrev_b32 v54, 2, v54
    ds_read_b32 v58, v54 offset:6144
    v_add_u32 v55, 128, v51
    v_lshlrev_b32 v55, 2, v55
    ds_read_b32 v59, v55 offset:6144
    s_waitcnt lgkmcnt(0)
    v_lshrrev_b32 v52, 2, v52
    v_cmp_le_u32 vcc, v56, v44
    s_nop 1
    v_cndmask_b32 v48, v48, v52, vcc
    v_lshrrev_b32 v53, 2, v53
    v_cmp_le_u32 vcc, v57, v45
    s_nop 1
    v_cndmask_b32 v49, v49, v53, vcc
    v_lshrrev_b32 v54, 2, v54
    v_cmp_le_u32 vcc, v58, v46
    s_nop 1
    v_cndmask_b32 v50, v50, v54, vcc
    v_lshrrev_b32 v55, 2, v55
    v_cmp_le_u32 vcc, v59, v47
    s_nop 1
    v_cndmask_b32 v51, v51, v55, vcc
    v_add_lshl_u32 v52, v48, 64, 2
    ds_read_b32 v56, v52 offset:6144
    v_add_lshl_u32 v53, v49, 64, 2
    ds_read_b32 v57, v53 offset:6144
    v_add_lshl_u32 v54, v50, 64, 2
    ds_read_b32 v58, v54 offset:6144
    v_add_lshl_u32 v55, v51, 64, 2
    ds_read_b32 v59, v55 offset:6144
    s_waitcnt lgkmcnt(0)
    v_lshrrev_b32 v52, 2, v52
    v_cmp_le_u32 vcc, v56, v44
    s_nop 1
    v_cndmask_b32 v48, v48, v52, vcc
    v_lshrrev_b32 v53, 2, v53
    v_cmp_le_u32 vcc, v57, v45
    s_nop 1
    v_cndmask_b32 v49, v49, v53, vcc
    v_lshrrev_b32 v54, 2, v54
    v_cmp_le_u32 vcc, v58, v46
    s_nop 1
    v_cndmask_b32 v50, v50, v54, vcc
    v_lshrrev_b32 v55, 2, v55
    v_cmp_le_u32 vcc, v59, v47
    s_nop 1
    v_cndmask_b32 v51, v51, v55, vcc
    v_add_lshl_u32 v52, v48, 32, 2
    ds_read_b32 v56, v52 offset:6144
    v_add_lshl_u32 v53, v49, 32, 2
    ds_read_b32 v57, v53 offset:6144
    v_add_lshl_u32 v54, v50, 32, 2
    ds_read_b32 v58, v54 offset:6144
    v_add_lshl_u32 v55, v51, 32, 2
    ds_read_b32 v59, v55 offset:6144
    s_waitcnt lgkmcnt(0)
    v_lshrrev_b32 v52, 2, v52
    v_cmp_le_u32 vcc, v56, v44
    s_nop 1
    v_cndmask_b32 v48, v48, v52, vcc
    v_lshrrev_b32 v53, 2, v53
    v_cmp_le_u32 vcc, v57, v45
    s_nop 1
    v_cndmask_b32 v49, v49, v53, vcc
    v_lshrrev_b32 v54, 2, v54
    v_cmp_le_u32 vcc, v58, v46
    s_nop 1
    v_cndmask_b32 v50, v50, v54, vcc
    v_lshrrev_b32 v55, 2, v55
    v_cmp_le_u32 vcc, v59, v47
    s_nop 1
    v_cndmask_b32 v51, v51, v55, vcc
    v_add_lshl_u32 v52, v48, 16, 2
    ds_read_b32 v56, v52 offset:6144
    v_add_lshl_u32 v53, v49, 16, 2
    ds_read_b32 v57, v53 offset:6144
    v_add_lshl_u32 v54, v50, 16, 2
    ds_read_b32 v58, v54 offset:6144
    v_add_lshl_u32 v55, v51, 16, 2
    ds_read_b32 v59, v55 offset:6144
    s_waitcnt lgkmcnt(0)
    v_lshrrev_b32 v52, 2, v52
    v_cmp_le_u32 vcc, v56, v44
    s_nop 1
    v_cndmask_b32 v48, v48, v52, vcc
    v_lshrrev_b32 v53, 2, v53
    v_cmp_le_u32 vcc, v57, v45
    s_nop 1
    v_cndmask_b32 v49, v49, v53, vcc
    v_lshrrev_b32 v54, 2, v54
    v_cmp_le_u32 vcc, v58, v46
    s_nop 1
    v_cndmask_b32 v50, v50, v54, vcc
    v_lshrrev_b32 v55, 2, v55
    v_cmp_le_u32 vcc, v59, v47
    s_nop 1
    v_cndmask_b32 v51, v51, v55, vcc
    v_add_lshl_u32 v52, v48, 8, 2
    ds_read_b32 v56, v52 offset:6144
    v_add_lshl_u32 v53, v49, 8, 2
    ds_read_b32 v57, v53 offset:6144
    v_add_lshl_u32 v54, v50, 8, 2
    ds_read_b32 v58, v54 offset:6144
    v_add_lshl_u32 v55, v51, 8, 2
    ds_read_b32 v59, v55 offset:6144
    s_waitcnt lgkmcnt(0)
    v_lshrrev_b32 v52, 2, v52
    v_cmp_le_u32 vcc, v56, v44
    s_nop 1
    v_cndmask_b32 v48, v48, v52, vcc
    v_lshrrev_b32 v53, 2, v53
    v_cmp_le_u32 vcc, v57, v45
    s_nop 1
    v_cndmask_b32 v49, v49, v53, vcc
    v_lshrrev_b32 v54, 2, v54
    v_cmp_le_u32 vcc, v58, v46
    s_nop 1
    v_cndmask_b32 v50, v50, v54, vcc
    v_lshrrev_b32 v55, 2, v55
    v_cmp_le_u32 vcc, v59, v47
    s_nop 1
    v_cndmask_b32 v51, v51, v55, vcc
    v_add_lshl_u32 v52, v48, 4, 2
    ds_read_b32 v56, v52 offset:6144
    v_add_lshl_u32 v53, v49, 4, 2
    ds_read_b32 v57, v53 offset:6144
    v_add_lshl_u32 v54, v50, 4, 2
    ds_read_b32 v58, v54 offset:6144
    v_add_lshl_u32 v55, v51, 4, 2
    ds_read_b32 v59, v55 offset:6144
    s_waitcnt lgkmcnt(0)
    v_lshrrev_b32 v52, 2, v52
    v_cmp_le_u32 vcc, v56, v44
    s_nop 1
    v_cndmask_b32 v48, v48, v52, vcc
    v_lshrrev_b32 v53, 2, v53
    v_cmp_le_u32 vcc, v57, v45
    s_nop 1
    v_cndmask_b32 v49, v49, v53, vcc
    v_lshrrev_b32 v54, 2, v54
    v_cmp_le_u32 vcc, v58, v46
    s_nop 1
    v_cndmask_b32 v50, v50, v54, vcc
    v_lshrrev_b32 v55, 2, v55
    v_cmp_le_u32 vcc, v59, v47
    s_nop 1
    v_cndmask_b32 v51, v51, v55, vcc
    v_add_lshl_u32 v52, v48, 2, 2
    ds_read_b32 v56, v52 offset:6144
    v_add_lshl_u32 v53, v49, 2, 2
    ds_read_b32 v57, v53 offset:6144
    v_add_lshl_u32 v54, v50, 2, 2
    ds_read_b32 v58, v54 offset:6144
    v_add_lshl_u32 v55, v51, 2, 2
    ds_read_b32 v59, v55 offset:6144
    s_waitcnt lgkmcnt(0)
    v_lshrrev_b32 v52, 2, v52
    v_cmp_le_u32 vcc, v56, v44
    s_nop 1
    v_cndmask_b32 v48, v48, v52, vcc
    v_lshrrev_b32 v53, 2, v53
    v_cmp_le_u32 vcc, v57, v45
    s_nop 1
    v_cndmask_b32 v49, v49, v53, vcc
    v_lshrrev_b32 v54, 2, v54
    v_cmp_le_u32 vcc, v58, v46
    s_nop 1
    v_cndmask_b32 v50, v50, v54, vcc
    v_lshrrev_b32 v55, 2, v55
    v_cmp_le_u32 vcc, v59, v47
    s_nop 1
    v_cndmask_b32 v51, v51, v55, vcc
    v_add_lshl_u32 v52, v48, 1, 2
    ds_read_b32 v56, v52 offset:6144
    v_add_lshl_u32 v53, v49, 1, 2
    ds_read_b32 v57, v53 offset:6144
    v_add_lshl_u32 v54, v50, 1, 2
    ds_read_b32 v58, v54 offset:6144
    v_add_lshl_u32 v55, v51, 1, 2
    ds_read_b32 v59, v55 offset:6144
    s_waitcnt lgkmcnt(0)
    v_lshrrev_b32 v52, 2, v52
    v_cmp_le_u32 vcc, v56, v44
    s_nop 1
    v_cndmask_b32 v48, v48, v52, vcc
    v_lshrrev_b32 v53, 2, v53
    v_cmp_le_u32 vcc, v57, v45
    s_nop 1
    v_cndmask_b32 v49, v49, v53, vcc
    v_lshrrev_b32 v54, 2, v54
    v_cmp_le_u32 vcc, v58, v46
    s_nop 1
    v_cndmask_b32 v50, v50, v54, vcc
    v_lshrrev_b32 v55, 2, v55
    v_cmp_le_u32 vcc, v59, v47
    s_nop 1
    v_cndmask_b32 v51, v51, v55, vcc
    v_lshlrev_b32 v48, 2, v48
    ds_read_b32 v48, v48 offset:8192
    v_lshlrev_b32 v49, 2, v49
    ds_read_b32 v49, v49 offset:8192
    v_lshlrev_b32 v50, 2, v50
    ds_read_b32 v50, v50 offset:8192
    v_lshlrev_b32 v51, 2, v51
    ds_read_b32 v51, v51 offset:8192
    s_waitcnt lgkmcnt(0)
    v_add_u32 v48, v48, v44
    v_add_u32 v49, v49, v45
    v_add_u32 v50, v50, v46
    v_add_u32 v51, v51, v47
    v_lshlrev_b32 v52, 2, v48
    v_lshlrev_b32 v48, 4, v48
    buffer_load_dword v56, v52, s[8:11], s20 offen
    buffer_load_dwordx4 v[64:67], v48, s[8:11], s21 offen
    v_lshlrev_b32 v53, 2, v49
    v_lshlrev_b32 v49, 4, v49
    buffer_load_dword v57, v53, s[8:11], s20 offen
    buffer_load_dwordx4 v[68:71], v49, s[8:11], s21 offen
    v_lshlrev_b32 v54, 2, v50
    v_lshlrev_b32 v50, 4, v50
    buffer_load_dword v58, v54, s[8:11], s20 offen
    buffer_load_dwordx4 v[72:75], v50, s[8:11], s21 offen
    v_lshlrev_b32 v55, 2, v51
    v_lshlrev_b32 v51, 4, v51
    buffer_load_dword v59, v55, s[8:11], s20 offen
    buffer_load_dwordx4 v[76:79], v51, s[8:11], s21 offen
    s_waitcnt vmcnt(0)
    v_bfe_u32 v52, v56, 16, 8
    v_lshlrev_b32 v52, 2, v52
    v_and_b32 v56, 0xffff, v56
    v_cmp_gt_u32 vcc, s13, v60
    s_and_saveexec_b64 s[14:15], vcc
    s_cbranch_execz kb_s0
    ds_add_rtn_u32 v52, v52, v3 offset:4096
    s_waitcnt lgkmcnt(0)
    v_lshlrev_b32 v48, 4, v52
    v_lshlrev_b32 v52, 2, v52
    buffer_store_dword v56, v52, s[8:11], s22 offen
    buffer_store_dwordx4 v[64:67], v48, s[8:11], s23 offen
kb_s0:
    s_mov_b64 exec, s[14:15]
    v_bfe_u32 v53, v57, 16, 8
    v_lshlrev_b32 v53, 2, v53
    v_and_b32 v57, 0xffff, v57
    v_cmp_gt_u32 vcc, s13, v61
    s_and_saveexec_b64 s[14:15], vcc
    s_cbranch_execz kb_s1
    ds_add_rtn_u32 v53, v53, v3 offset:4096
    s_waitcnt lgkmcnt(0)
    v_lshlrev_b32 v49, 4, v53
    v_lshlrev_b32 v53, 2, v53
    buffer_store_dword v57, v53, s[8:11], s22 offen
    buffer_store_dwordx4 v[68:71], v49, s[8:11], s23 offen
kb_s1:
    s_mov_b64 exec, s[14:15]
    v_bfe_u32 v54, v58, 16, 8
    v_lshlrev_b32 v54, 2, v54
    v_and_b32 v58, 0xffff, v58
    v_cmp_gt_u32 vcc, s13, v62
    s_and_saveexec_b64 s[14:15], vcc
    s_cbranch_execz kb_s2
    ds_add_rtn_u32 v54, v54, v3 offset:4096
    s_waitcnt lgkmcnt(0)
    v_lshlrev_b32 v50, 4, v54
    v_lshlrev_b32 v54, 2, v54
    buffer_store_dword v58, v54, s[8:11], s22 offen
    buffer_store_dwordx4 v[72:75], v50, s[8:11], s23 offen
kb_s2:
    s_mov_b64 exec, s[14:15]
    v_bfe_u32 v55, v59, 16, 8
    v_lshlrev_b32 v55, 2, v55
    v_and_b32 v59, 0xffff, v59
    v_cmp_gt_u32 vcc, s13, v63
    s_and_saveexec_b64 s[14:15], vcc
    s_cbranch_execz kb_s3
    ds_add_rtn_u32 v55, v55, v3 offset:4096
    s_waitcnt lgkmcnt(0)
    v_lshlrev_b32 v51, 4, v55
    v_lshlrev_b32 v55, 2, v55
    buffer_store_dword v59, v55, s[8:11], s22 offen
    buffer_store_dwordx4 v[76:79], v51, s[8:11], s23 offen
kb_s3:
    s_mov_b64 exec, s[14:15]
    v_add_u32 v4, 4096, v4
    s_branch kb_l2
kb_end:
    s_endpgm
.globl k4m_kernel
.p2align 8
.type k4m_kernel,@function
k4m_kernel:
    v_lshrrev_b32 v1, 6, v0
    s_nop 0
    v_readfirstlane_b32 s3, v1
    s_lshl_b32 s2, s2, 2
    s_mov_b32 s65, s2
    s_mov_b32 s64, s3
    s_add_u32 s2, s2, s3
    s_cmp_ge_u32 s2, 50000
    s_cbranch_scc1 km_end
    s_load_dwordx2 s[66:67], s[0:1], 64
    s_load_dwordx2 s[4:5], s[0:1], 0
    s_load_dwordx4 s[20:23], s[0:1], 40
    s_load_dwordx2 s[6:7], s[0:1], 80
    s_waitcnt lgkmcnt(0)
    s_mov_b32 s8, s4
    s_and_b32 s9, s5, 0xffff
    s_mov_b32 s10, 0x186a000
    s_mov_b32 s11, 0x00020000
    s_mov_b32 s12, s6
    s_and_b32 s13, s7, 0xffff
    s_mov_b32 s14, 0x10000000
    s_mov_b32 s15, 0x00020000
    s_mov_b32 s24, s20
    s_and_b32 s25, s21, 0xffff
    s_mov_b32 s26, 0x80
    s_mov_b32 s27, 0x00020000
    s_mov_b32 s28, s22
    s_and_b32 s29, s23, 0xffff
    s_mov_b32 s30, 0x200
    s_mov_b32 s31, 0x00020000
    s_mov_b32 s68, s66
    s_and_b32 s69, s67, 0xffff
    s_mov_b32 s70, 0x186a000
    s_mov_b32 s71, 0x00020000
    s_lshl_b32 s3, s2, 2
    s_add_u32 s3, s3, 16384
    s_add_u32 s16, s6, s3
    s_addc_u32 s17, s7, 0
    s_load_dwordx2 s[18:19], s[16:17], 0
    v_and_b32 v0, 63, v0
    v_lshlrev_b32 v1, 2, v0
    v_and_b32 v2, 31, v0
    v_lshlrev_b32 v2, 2, v2
    buffer_load_dword v32, v2, s[28:31], 0 offen offset:0
    buffer_load_dword v33, v2, s[28:31], 0 offen offset:128
    buffer_load_dword v34, v2, s[28:31], 0 offen offset:256
    buffer_load_dword v35, v2, s[28:31], 0 offen offset:384
    v_lshrrev_b32 v3, 5, v0
    v_lshlrev_b32 v3, 5, v3
    buffer_load_dwordx4 v[8:11], v3, s[24:27], 0 offen offset:0
    buffer_load_dwordx4 v[12:15], v3, s[24:27], 0 offen offset:16
    buffer_load_dwordx4 v[64:67], v3, s[24:27], 0 offen offset:64
    buffer_load_dwordx4 v[68:71], v3, s[24:27], 0 offen offset:80
    s_waitcnt vmcnt(4)
    v_lshlrev_b32 v16, 16, v32
    v_and_b32 v17, 0xffff0000, v32
    v_lshlrev_b32 v18, 16, v33
    v_and_b32 v19, 0xffff0000, v33
    v_lshlrev_b32 v20, 16, v34
    v_and_b32 v21, 0xffff0000, v34
    v_lshlrev_b32 v22, 16, v35
    v_and_b32 v23, 0xffff0000, v35
    v_mov_b32 v32, 0
    v_mov_b32 v33, 0
    v_mov_b32 v34, 0
    v_mov_b32 v35, 0
    v_mov_b32 v36, 0
    v_mov_b32 v37, 0
    v_mov_b32 v38, 0
    v_mov_b32 v39, 0
    v_mov_b32 v40, 0
    v_mov_b32 v41, 0
    v_mov_b32 v42, 0
    v_mov_b32 v43, 0
    v_mov_b32 v44, 0
    v_mov_b32 v45, 0
    v_mov_b32 v46, 0
    v_mov_b32 v47, 0
    s_waitcnt lgkmcnt(0)
    s_mov_b32 s32, 18874368
    s_mov_b32 s33, 23068672
    s_mov_b32 s34, s18
km_batch:
    s_sub_u32 s35, s19, s34
    s_cmp_eq_u32 s35, 0
    s_cbranch_scc1 km_done
    s_lshl_b32 s39, s34, 4
    s_add_u32 s39, s39, 23068672
    s_add_u32 s16, s12, s39
    s_addc_u32 s17, s13, 0
    s_lshl_b32 s39, s34, 2
    s_add_u32 s39, s39, 18874368
    s_add_u32 s96, s12, s39
    s_addc_u32 s97, s13, 0
    s_load_dwordx8 s[24:31], s[96:97], 0
    s_load_dwordx16 s[72:87], s[16:17], 0
    s_waitcnt lgkmcnt(0)
    s_lshl_b32 s40, s24, 9
    s_cmp_le_u32 s35, 0
    s_cselect_b32 s40, 0x7f000000, s40
    s_lshl_b32 s41, s25, 9
    s_cmp_le_u32 s35, 1
    s_cselect_b32 s41, 0x7f000000, s41
    s_lshl_b32 s42, s26, 9
    s_cmp_le_u32 s35, 2
    s_cselect_b32 s42, 0x7f000000, s42
    s_lshl_b32 s43, s27, 9
    s_cmp_le_u32 s35, 3
    s_cselect_b32 s43, 0x7f000000, s43
    s_lshl_b32 s44, s28, 9
    s_cmp_le_u32 s35, 4
    s_cselect_b32 s44, 0x7f000000, s44
    s_lshl_b32 s45, s29, 9
    s_cmp_le_u32 s35, 5
    s_cselect_b32 s45, 0x7f000000, s45
    s_lshl_b32 s46, s30, 9
    s_cmp_le_u32 s35, 6
    s_cselect_b32 s46, 0x7f000000, s46
    s_lshl_b32 s47, s31, 9
    s_cmp_le_u32 s35, 7
    s_cselect_b32 s47, 0x7f000000, s47
    s_load_dwordx8 s[24:31], s[96:97], 32
    buffer_load_dword v48, v1, s[8:11], s40 offen
    buffer_load_dword v49, v1, s[8:11], s40 offen offset:256
    buffer_load_dword v50, v1, s[8:11], s41 offen
    buffer_load_dword v51, v1, s[8:11], s41 offen offset:256
    buffer_load_dword v52, v1, s[8:11], s42 offen
    buffer_load_dword v53, v1, s[8:11], s42 offen offset:256
    buffer_load_dword v54, v1, s[8:11], s43 offen
    buffer_load_dword v55, v1, s[8:11], s43 offen offset:256
    buffer_load_dword v56, v1, s[8:11], s44 offen
    buffer_load_dword v57, v1, s[8:11], s44 offen offset:256
    buffer_load_dword v58, v1, s[8:11], s45 offen
    buffer_load_dword v59, v1, s[8:11], s45 offen offset:256
    buffer_load_dword v60, v1, s[8:11], s46 offen
    buffer_load_dword v61, v1, s[8:11], s46 offen offset:256
    buffer_load_dword v62, v1, s[8:11], s47 offen
    buffer_load_dword v63, v1, s[8:11], s47 offen offset:256
    s_mov_b32 s38, 0
km_loop:
    s_waitcnt lgkmcnt(0)
    s_lshl_b32 s88, s24, 9
    s_add_u32 s39, s38, 8
    s_cmp_ge_u32 s39, s35
    s_cselect_b32 s88, 0x7f000000, s88
    s_lshl_b32 s89, s25, 9
    s_add_u32 s39, s38, 9
    s_cmp_ge_u32 s39, s35
    s_cselect_b32 s89, 0x7f000000, s89
    s_lshl_b32 s90, s26, 9
    s_add_u32 s39, s38, 10
    s_cmp_ge_u32 s39, s35
    s_cselect_b32 s90, 0x7f000000, s90
    s_lshl_b32 s91, s27, 9
    s_add_u32 s39, s38, 11
    s_cmp_ge_u32 s39, s35
    s_cselect_b32 s91, 0x7f000000, s91
    s_lshl_b32 s92, s28, 9
    s_add_u32 s39, s38, 12
    s_cmp_ge_u32 s39, s35
    s_cselect_b32 s92, 0x7f000000, s92
    s_lshl_b32 s93, s29, 9
    s_add_u32 s39, s38, 13
    s_cmp_ge_u32 s39, s35
    s_cselect_b32 s93, 0x7f000000, s93
    s_lshl_b32 s94, s30, 9
    s_add_u32 s39, s38, 14
    s_cmp_ge_u32 s39, s35
    s_cselect_b32 s94, 0x7f000000, s94
    s_lshl_b32 s95, s31, 9
    s_add_u32 s39, s38, 15
    s_cmp_ge_u32 s39, s35
    s_cselect_b32 s95, 0x7f000000, s95
    s_load_dwordx8 s[24:31], s[96:97], 64
    s_load_dwordx16 s[48:63], s[16:17], 64
    s_lshl_b32 s20, s72, 16
    s_and_b32 s21, s72, 0xffff0000
    s_lshl_b32 s22, s73, 16
    s_and_b32 s23, s73, 0xffff0000
    s_lshl_b32 s4, s74, 16
    s_and_b32 s5, s74, 0xffff0000
    s_lshl_b32 s6, s75, 16
    s_and_b32 s7, s75, 0xffff0000
    s_waitcnt vmcnt(14)
    v_lshlrev_b32 v24, 16, v48
    v_and_b32 v25, 0xffff0000, v48
    v_lshlrev_b32 v26, 16, v49
    v_and_b32 v27, 0xffff0000, v49
    buffer_load_dword v48, v1, s[8:11], s88 offen
    buffer_load_dword v49, v1, s[8:11], s88 offen offset:256
    v_pk_mul_f32 v[28:29], s[4:5], v[16:17] op_sel:[0,0] op_sel_hi:[0,1]
    v_pk_fma_f32 v[28:29], s[4:5], v[18:19], v[28:29] op_sel:[1,0,0] op_sel_hi:[1,1,1]
    v_pk_fma_f32 v[28:29], s[6:7], v[20:21], v[28:29] op_sel:[0,0,0] op_sel_hi:[0,1,1]
    v_pk_fma_f32 v[28:29], s[6:7], v[22:23], v[28:29] op_sel:[1,0,0] op_sel_hi:[1,1,1]
    v_pk_mul_f32 v[24:25], v[28:29], v[24:25]
    v_pk_mul_f32 v[26:27], v[28:29], v[26:27]
    v_pk_fma_f32 v[32:33], s[20:21], v[24:25], v[32:33] op_sel:[0,0,0] op_sel_hi:[0,1,1]
    v_pk_fma_f32 v[40:41], s[20:21], v[26:27], v[40:41] op_sel:[0,0,0] op_sel_hi:[0,1,1]
    v_pk_fma_f32 v[34:35], s[20:21], v[24:25], v[34:35] op_sel:[1,0,0] op_sel_hi:[1,1,1]
    v_pk_fma_f32 v[42:43], s[20:21], v[26:27], v[42:43] op_sel:[1,0,0] op_sel_hi:[1,1,1]
    v_pk_fma_f32 v[36:37], s[22:23], v[24:25], v[36:37] op_sel:[0,0,0] op_sel_hi:[0,1,1]
    v_pk_fma_f32 v[44:45], s[22:23], v[26:27], v[44:45] op_sel:[0,0,0] op_sel_hi:[0,1,1]
    v_pk_fma_f32 v[38:39], s[22:23], v[24:25], v[38:39] op_sel:[1,0,0] op_sel_hi:[1,1,1]
    v_pk_fma_f32 v[46:47], s[22:23], v[26:27], v[46:47] op_sel:[1,0,0] op_sel_hi:[1,1,1]
    s_add_u32 s39, s38, 1
    s_cmp_ge_u32 s39, s35
    s_cbranch_scc1 km_bend
    s_lshl_b32 s20, s76, 16
    s_and_b32 s21, s76, 0xffff0000
    s_lshl_b32 s22, s77, 16
    s_and_b32 s23, s77, 0xffff0000
    s_lshl_b32 s4, s78, 16
    s_and_b32 s5, s78, 0xffff0000
    s_lshl_b32 s6, s79, 16
    s_and_b32 s7, s79, 0xffff0000
    s_waitcnt vmcnt(14)
    v_lshlrev_b32 v24, 16, v50
    v_and_b32 v25, 0xffff0000, v50
    v_lshlrev_b32 v26, 16, v51
    v_and_b32 v27, 0xffff0000, v51
    buffer_load_dword v50, v1, s[8:11], s89 offen
    buffer_load_dword v51, v1, s[8:11], s89 offen offset:256
    v_pk_mul_f32 v[28:29], s[4:5], v[16:17] op_sel:[0,0] op_sel_hi:[0,1]
    v_pk_fma_f32 v[28:29], s[4:5], v[18:19], v[28:29] op_sel:[1,0,0] op_sel_hi:[1,1,1]
    v_pk_fma_f32 v[28:29], s[6:7], v[20:21], v[28:29] op_sel:[0,0,0] op_sel_hi:[0,1,1]
    v_pk_fma_f32 v[28:29], s[6:7], v[22:23], v[28:29] op_sel:[1,0,0] op_sel_hi:[1,1,1]
    v_pk_mul_f32 v[24:25], v[28:29], v[24:25]
    v_pk_mul_f32 v[26:27], v[28:29], v[26:27]
    v_pk_fma_f32 v[32:33], s[20:21], v[24:25], v[32:33] op_sel:[0,0,0] op_sel_hi:[0,1,1]
    v_pk_fma_f32 v[40:41], s[20:21], v[26:27], v[40:41] op_sel:[0,0,0] op_sel_hi:[0,1,1]
    v_pk_fma_f32 v[34:35], s[20:21], v[24:25], v[34:35] op_sel:[1,0,0] op_sel_hi:[1,1,1]
    v_pk_fma_f32 v[42:43], s[20:21], v[26:27], v[42:43] op_sel:[1,0,0] op_sel_hi:[1,1,1]
    v_pk_fma_f32 v[36:37], s[22:23], v[24:25], v[36:37] op_sel:[0,0,0] op_sel_hi:[0,1,1]
    v_pk_fma_f32 v[44:45], s[22:23], v[26:27], v[44:45] op_sel:[0,0,0] op_sel_hi:[0,1,1]
    v_pk_fma_f32 v[38:39], s[22:23], v[24:25], v[38:39] op_sel:[1,0,0] op_sel_hi:[1,1,1]
    v_pk_fma_f32 v[46:47], s[22:23], v[26:27], v[46:47] op_sel:[1,0,0] op_sel_hi:[1,1,1]
    s_add_u32 s39, s38, 2
    s_cmp_ge_u32 s39, s35
    s_cbranch_scc1 km_bend
    s_lshl_b32 s20, s80, 16
    s_and_b32 s21, s80, 0xffff0000
    s_lshl_b32 s22, s81, 16
    s_and_b32 s23, s81, 0xffff0000
    s_lshl_b32 s4, s82, 16
    s_and_b32 s5, s82, 0xffff0000
    s_lshl_b32 s6, s83, 16
    s_and_b32 s7, s83, 0xffff0000
    s_waitcnt vmcnt(14)
    v_lshlrev_b32 v24, 16, v52
    v_and_b32 v25, 0xffff0000, v52
    v_lshlrev_b32 v26, 16, v53
    v_and_b32 v27, 0xffff0000, v53
    buffer_load_dword v52, v1, s[8:11], s90 offen
    buffer_load_dword v53, v1, s[8:11], s90 offen offset:256
    v_pk_mul_f32 v[28:29], s[4:5], v[16:17] op_sel:[0,0] op_sel_hi:[0,1]
    v_pk_fma_f32 v[28:29], s[4:5], v[18:19], v[28:29] op_sel:[1,0,0] op_sel_hi:[1,1,1]
    v_pk_fma_f32 v[28:29], s[6:7], v[20:21], v[28:29] op_sel:[0,0,0] op_sel_hi:[0,1,1]
    v_pk_fma_f32 v[28:29], s[6:7], v[22:23], v[28:29] op_sel:[1,0,0] op_sel_hi:[1,1,1]
    v_pk_mul_f32 v[24:25], v[28:29], v[24:25]
    v_pk_mul_f32 v[26:27], v[28:29], v[26:27]
    v_pk_fma_f32 v[32:33], s[20:21], v[24:25], v[32:33] op_sel:[0,0,0] op_sel_hi:[0,1,1]
    v_pk_fma_f32 v[40:41], s[20:21], v[26:27], v[40:41] op_sel:[0,0,0] op_sel_hi:[0,1,1]
    v_pk_fma_f32 v[34:35], s[20:21], v[24:25], v[34:35] op_sel:[1,0,0] op_sel_hi:[1,1,1]
    v_pk_fma_f32 v[42:43], s[20:21], v[26:27], v[42:43] op_sel:[1,0,0] op_sel_hi:[1,1,1]
    v_pk_fma_f32 v[36:37], s[22:23], v[24:25], v[36:37] op_sel:[0,0,0] op_sel_hi:[0,1,1]
    v_pk_fma_f32 v[44:45], s[22:23], v[26:27], v[44:45] op_sel:[0,0,0] op_sel_hi:[0,1,1]
    v_pk_fma_f32 v[38:39], s[22:23], v[24:25], v[38:39] op_sel:[1,0,0] op_sel_hi:[1,1,1]
    v_pk_fma_f32 v[46:47], s[22:23], v[26:27], v[46:47] op_sel:[1,0,0] op_sel_hi:[1,1,1]
    s_add_u32 s39, s38, 3
    s_cmp_ge_u32 s39, s35
    s_cbranch_scc1 km_bend
    s_lshl_b32 s20, s84, 16
    s_and_b32 s21, s84, 0xffff0000
    s_lshl_b32 s22, s85, 16
    s_and_b32 s23, s85, 0xffff0000
    s_lshl_b32 s4, s86, 16
    s_and_b32 s5, s86, 0xffff0000
    s_lshl_b32 s6, s87, 16
    s_and_b32 s7, s87, 0xffff0000
    s_waitcnt vmcnt(14)
    v_lshlrev_b32 v24, 16, v54
    v_and_b32 v25, 0xffff0000, v54
    v_lshlrev_b32 v26, 16, v55
    v_and_b32 v27, 0xffff0000, v55
    buffer_load_dword v54, v1, s[8:11], s91 offen
    buffer_load_dword v55, v1, s[8:11], s91 offen offset:256
    v_pk_mul_f32 v[28:29], s[4:5], v[16:17] op_sel:[0,0] op_sel_hi:[0,1]
    v_pk_fma_f32 v[28:29], s[4:5], v[18:19], v[28:29] op_sel:[1,0,0] op_sel_hi:[1,1,1]
    v_pk_fma_f32 v[28:29], s[6:7], v[20:21], v[28:29] op_sel:[0,0,0] op_sel_hi:[0,1,1]
    v_pk_fma_f32 v[28:29], s[6:7], v[22:23], v[28:29] op_sel:[1,0,0] op_sel_hi:[1,1,1]
    v_pk_mul_f32 v[24:25], v[28:29], v[24:25]
    v_pk_mul_f32 v[26:27], v[28:29], v[26:27]
    v_pk_fma_f32 v[32:33], s[20:21], v[24:25], v[32:33] op_sel:[0,0,0] op_sel_hi:[0,1,1]
    v_pk_fma_f32 v[40:41], s[20:21], v[26:27], v[40:41] op_sel:[0,0,0] op_sel_hi:[0,1,1]
    v_pk_fma_f32 v[34:35], s[20:21], v[24:25], v[34:35] op_sel:[1,0,0] op_sel_hi:[1,1,1]
    v_pk_fma_f32 v[42:43], s[20:21], v[26:27], v[42:43] op_sel:[1,0,0] op_sel_hi:[1,1,1]
    v_pk_fma_f32 v[36:37], s[22:23], v[24:25], v[36:37] op_sel:[0,0,0] op_sel_hi:[0,1,1]
    v_pk_fma_f32 v[44:45], s[22:23], v[26:27], v[44:45] op_sel:[0,0,0] op_sel_hi:[0,1,1]
    v_pk_fma_f32 v[38:39], s[22:23], v[24:25], v[38:39] op_sel:[1,0,0] op_sel_hi:[1,1,1]
    v_pk_fma_f32 v[46:47], s[22:23], v[26:27], v[46:47] op_sel:[1,0,0] op_sel_hi:[1,1,1]
    s_add_u32 s39, s38, 4
    s_cmp_ge_u32 s39, s35
    s_cbranch_scc1 km_bend
    s_waitcnt lgkmcnt(0)
    s_load_dwordx16 s[72:87], s[16:17], 128
    s_lshl_b32 s20, s48, 16
    s_and_b32 s21, s48, 0xffff0000
    s_lshl_b32 s22, s49, 16
    s_and_b32 s23, s49, 0xffff0000
    s_lshl_b32 s4, s50, 16
    s_and_b32 s5, s50, 0xffff0000
    s_lshl_b32 s6, s51, 16
    s_and_b32 s7, s51, 0xffff0000
    s_waitcnt vmcnt(14)
    v_lshlrev_b32 v24, 16, v56
    v_and_b32 v25, 0xffff0000, v56
    v_lshlrev_b32 v26, 16, v57
    v_and_b32 v27, 0xffff0000, v57
    buffer_load_dword v56, v1, s[8:11], s92 offen
    buffer_load_dword v57, v1, s[8:11], s92 offen offset:256
    v_pk_mul_f32 v[28:29], s[4:5], v[16:17] op_sel:[0,0] op_sel_hi:[0,1]
    v_pk_fma_f32 v[28:29], s[4:5], v[18:19], v[28:29] op_sel:[1,0,0] op_sel_hi:[1,1,1]
    v_pk_fma_f32 v[28:29], s[6:7], v[20:21], v[28:29] op_sel:[0,0,0] op_sel_hi:[0,1,1]
    v_pk_fma_f32 v[28:29], s[6:7], v[22:23], v[28:29] op_sel:[1,0,0] op_sel_hi:[1,1,1]
    v_pk_mul_f32 v[24:25], v[28:29], v[24:25]
    v_pk_mul_f32 v[26:27], v[28:29], v[26:27]
    v_pk_fma_f32 v[32:33], s[20:21], v[24:25], v[32:33] op_sel:[0,0,0] op_sel_hi:[0,1,1]
    v_pk_fma_f32 v[40:41], s[20:21], v[26:27], v[40:41] op_sel:[0,0,0] op_sel_hi:[0,1,1]
    v_pk_fma_f32 v[34:35], s[20:21], v[24:25], v[34:35] op_sel:[1,0,0] op_sel_hi:[1,1,1]
    v_pk_fma_f32 v[42:43], s[20:21], v[26:27], v[42:43] op_sel:[1,0,0] op_sel_hi:[1,1,1]
    v_pk_fma_f32 v[36:37], s[22:23], v[24:25], v[36:37] op_sel:[0,0,0] op_sel_hi:[0,1,1]
    v_pk_fma_f32 v[44:45], s[22:23], v[26:27], v[44:45] op_sel:[0,0,0] op_sel_hi:[0,1,1]
    v_pk_fma_f32 v[38:39], s[22:23], v[24:25], v[38:39] op_sel:[1,0,0] op_sel_hi:[1,1,1]
    v_pk_fma_f32 v[46:47], s[22:23], v[26:27], v[46:47] op_sel:[1,0,0] op_sel_hi:[1,1,1]
    s_add_u32 s39, s38, 5
    s_cmp_ge_u32 s39, s35
    s_cbranch_scc1 km_bend
    s_lshl_b32 s20, s52, 16
    s_and_b32 s21, s52, 0xffff0000
    s_lshl_b32 s22, s53, 16
    s_and_b32 s23, s53, 0xffff0000
    s_lshl_b32 s4, s54, 16
    s_and_b32 s5, s54, 0xffff0000
    s_lshl_b32 s6, s55, 16
    s_and_b32 s7, s55, 0xffff0000
    s_waitcnt vmcnt(14)
    v_lshlrev_b32 v24, 16, v58
    v_and_b32 v25, 0xffff0000, v58
    v_lshlrev_b32 v26, 16, v59
    v_and_b32 v27, 0xffff0000, v59
    buffer_load_dword v58, v1, s[8:11], s93 offen
    buffer_load_dword v59, v1, s[8:11], s93 offen offset:256
    v_pk_mul_f32 v[28:29], s[4:5], v[16:17] op_sel:[0,0] op_sel_hi:[0,1]
    v_pk_fma_f32 v[28:29], s[4:5], v[18:19], v[28:29] op_sel:[1,0,0] op_sel_hi:[1,1,1]
    v_pk_fma_f32 v[28:29], s[6:7], v[20:21], v[28:29] op_sel:[0,0,0] op_sel_hi:[0,1,1]
    v_pk_fma_f32 v[28:29], s[6:7], v[22:23], v[28:29] op_sel:[1,0,0] op_sel_hi:[1,1,1]
    v_pk_mul_f32 v[24:25], v[28:29], v[24:25]
    v_pk_mul_f32 v[26:27], v[28:29], v[26:27]
    v_pk_fma_f32 v[32:33], s[20:21], v[24:25], v[32:33] op_sel:[0,0,0] op_sel_hi:[0,1,1]
    v_pk_fma_f32 v[40:41], s[20:21], v[26:27], v[40:41] op_sel:[0,0,0] op_sel_hi:[0,1,1]
    v_pk_fma_f32 v[34:35], s[20:21], v[24:25], v[34:35] op_sel:[1,0,0] op_sel_hi:[1,1,1]
    v_pk_fma_f32 v[42:43], s[20:21], v[26:27], v[42:43] op_sel:[1,0,0] op_sel_hi:[1,1,1]
    v_pk_fma_f32 v[36:37], s[22:23], v[24:25], v[36:37] op_sel:[0,0,0] op_sel_hi:[0,1,1]
    v_pk_fma_f32 v[44:45], s[22:23], v[26:27], v[44:45] op_sel:[0,0,0] op_sel_hi:[0,1,1]
    v_pk_fma_f32 v[38:39], s[22:23], v[24:25], v[38:39] op_sel:[1,0,0] op_sel_hi:[1,1,1]
    v_pk_fma_f32 v[46:47], s[22:23], v[26:27], v[46:47] op_sel:[1,0,0] op_sel_hi:[1,1,1]
    s_add_u32 s39, s38, 6
    s_cmp_ge_u32 s39, s35
    s_cbranch_scc1 km_bend
    s_lshl_b32 s20, s56, 16
    s_and_b32 s21, s56, 0xffff0000
    s_lshl_b32 s22, s57, 16
    s_and_b32 s23, s57, 0xffff0000
    s_lshl_b32 s4, s58, 16
    s_and_b32 s5, s58, 0xffff0000
    s_lshl_b32 s6, s59, 16
    s_and_b32 s7, s59, 0xffff0000
    s_waitcnt vmcnt(14)
    v_lshlrev_b32 v24, 16, v60
    v_and_b32 v25, 0xffff0000, v60
    v_lshlrev_b32 v26, 16, v61
    v_and_b32 v27, 0xffff0000, v61
    buffer_load_dword v60, v1, s[8:11], s94 offen
    buffer_load_dword v61, v1, s[8:11], s94 offen offset:256
    v_pk_mul_f32 v[28:29], s[4:5], v[16:17] op_sel:[0,0] op_sel_hi:[0,1]
    v_pk_fma_f32 v[28:29], s[4:5], v[18:19], v[28:29] op_sel:[1,0,0] op_sel_hi:[1,1,1]
    v_pk_fma_f32 v[28:29], s[6:7], v[20:21], v[28:29] op_sel:[0,0,0] op_sel_hi:[0,1,1]
    v_pk_fma_f32 v[28:29], s[6:7], v[22:23], v[28:29] op_sel:[1,0,0] op_sel_hi:[1,1,1]
    v_pk_mul_f32 v[24:25], v[28:29], v[24:25]
    v_pk_mul_f32 v[26:27], v[28:29], v[26:27]
    v_pk_fma_f32 v[32:33], s[20:21], v[24:25], v[32:33] op_sel:[0,0,0] op_sel_hi:[0,1,1]
    v_pk_fma_f32 v[40:41], s[20:21], v[26:27], v[40:41] op_sel:[0,0,0] op_sel_hi:[0,1,1]
    v_pk_fma_f32 v[34:35], s[20:21], v[24:25], v[34:35] op_sel:[1,0,0] op_sel_hi:[1,1,1]
    v_pk_fma_f32 v[42:43], s[20:21], v[26:27], v[42:43] op_sel:[1,0,0] op_sel_hi:[1,1,1]
    v_pk_fma_f32 v[36:37], s[22:23], v[24:25], v[36:37] op_sel:[0,0,0] op_sel_hi:[0,1,1]
    v_pk_fma_f32 v[44:45], s[22:23], v[26:27], v[44:45] op_sel:[0,0,0] op_sel_hi:[0,1,1]
    v_pk_fma_f32 v[38:39], s[22:23], v[24:25], v[38:39] op_sel:[1,0,0] op_sel_hi:[1,1,1]
    v_pk_fma_f32 v[46:47], s[22:23], v[26:27], v[46:47] op_sel:[1,0,0] op_sel_hi:[1,1,1]
    s_add_u32 s39, s38, 7
    s_cmp_ge_u32 s39, s35
    s_cbranch_scc1 km_bend
    s_lshl_b32 s20, s60, 16
    s_and_b32 s21, s60, 0xffff0000
    s_lshl_b32 s22, s61, 16
    s_and_b32 s23, s61, 0xffff0000
    s_lshl_b32 s4, s62, 16
    s_and_b32 s5, s62, 0xffff0000
    s_lshl_b32 s6, s63, 16
    s_and_b32 s7, s63, 0xffff0000
    s_waitcnt vmcnt(14)
    v_lshlrev_b32 v24, 16, v62
    v_and_b32 v25, 0xffff0000, v62
    v_lshlrev_b32 v26, 16, v63
    v_and_b32 v27, 0xffff0000, v63
    buffer_load_dword v62, v1, s[8:11], s95 offen
    buffer_load_dword v63, v1, s[8:11], s95 offen offset:256
    v_pk_mul_f32 v[28:29], s[4:5], v[16:17] op_sel:[0,0] op_sel_hi:[0,1]
    v_pk_fma_f32 v[28:29], s[4:5], v[18:19], v[28:29] op_sel:[1,0,0] op_sel_hi:[1,1,1]
    v_pk_fma_f32 v[28:29], s[6:7], v[20:21], v[28:29] op_sel:[0,0,0] op_sel_hi:[0,1,1]
    v_pk_fma_f32 v[28:29], s[6:7], v[22:23], v[28:29] op_sel:[1,0,0] op_sel_hi:[1,1,1]
    v_pk_mul_f32 v[24:25], v[28:29], v[24:25]
    v_pk_mul_f32 v[26:27], v[28:29], v[26:27]
    v_pk_fma_f32 v[32:33], s[20:21], v[24:25], v[32:33] op_sel:[0,0,0] op_sel_hi:[0,1,1]
    v_pk_fma_f32 v[40:41], s[20:21], v[26:27], v[40:41] op_sel:[0,0,0] op_sel_hi:[0,1,1]
    v_pk_fma_f32 v[34:35], s[20:21], v[24:25], v[34:35] op_sel:[1,0,0] op_sel_hi:[1,1,1]
    v_pk_fma_f32 v[42:43], s[20:21], v[26:27], v[42:43] op_sel:[1,0,0] op_sel_hi:[1,1,1]
    v_pk_fma_f32 v[36:37], s[22:23], v[24:25], v[36:37] op_sel:[0,0,0] op_sel_hi:[0,1,1]
    v_pk_fma_f32 v[44:45], s[22:23], v[26:27], v[44:45] op_sel:[0,0,0] op_sel_hi:[0,1,1]
    v_pk_fma_f32 v[38:39], s[22:23], v[24:25], v[38:39] op_sel:[1,0,0] op_sel_hi:[1,1,1]
    v_pk_fma_f32 v[46:47], s[22:23], v[26:27], v[46:47] op_sel:[1,0,0] op_sel_hi:[1,1,1]
    s_add_u32 s16, s16, 128
    s_addc_u32 s17, s17, 0
    s_add_u32 s96, s96, 32
    s_addc_u32 s97, s97, 0
    s_add_u32 s38, s38, 8
    s_cmp_lt_u32 s38, s35
    s_cbranch_scc1 km_loop
km_bend:
    s_waitcnt vmcnt(0) lgkmcnt(0)
km_done:
    s_waitcnt vmcnt(0)
    v_lshlrev_b32 v48, 16, v8
    v_and_b32 v49, 0xffff0000, v8
    v_lshlrev_b32 v50, 16, v9
    v_and_b32 v51, 0xffff0000, v9
    v_pk_mul_f32 v[16:17], v[48:49], v[32:33] op_sel:[0,0] op_sel_hi:[0,1]
    v_pk_mul_f32 v[18:19], v[48:49], v[32:33] op_sel:[1,0] op_sel_hi:[1,1]
    v_pk_mul_f32 v[20:21], v[50:51], v[32:33] op_sel:[0,0] op_sel_hi:[0,1]
    v_pk_mul_f32 v[22:23], v[50:51], v[32:33] op_sel:[1,0] op_sel_hi:[1,1]
    v_lshlrev_b32 v48, 16, v10
    v_and_b32 v49, 0xffff0000, v10
    v_lshlrev_b32 v50, 16, v11
    v_and_b32 v51, 0xffff0000, v11
    v_pk_fma_f32 v[16:17], v[48:49], v[34:35], v[16:17] op_sel:[0,0,0] op_sel_hi:[0,1,1]
    v_pk_fma_f32 v[18:19], v[48:49], v[34:35], v[18:19] op_sel:[1,0,0] op_sel_hi:[1,1,1]
    v_pk_fma_f32 v[20:21], v[50:51], v[34:35], v[20:21] op_sel:[0,0,0] op_sel_hi:[0,1,1]
    v_pk_fma_f32 v[22:23], v[50:51], v[34:35], v[22:23] op_sel:[1,0,0] op_sel_hi:[1,1,1]
    v_lshlrev_b32 v48, 16, v12
    v_and_b32 v49, 0xffff0000, v12
    v_lshlrev_b32 v50, 16, v13
    v_and_b32 v51, 0xffff0000, v13
    v_pk_fma_f32 v[16:17], v[48:49], v[36:37], v[16:17] op_sel:[0,0,0] op_sel_hi:[0,1,1]
    v_pk_fma_f32 v[18:19], v[48:49], v[36:37], v[18:19] op_sel:[1,0,0] op_sel_hi:[1,1,1]
    v_pk_fma_f32 v[20:21], v[50:51], v[36:37], v[20:21] op_sel:[0,0,0] op_sel_hi:[0,1,1]
    v_pk_fma_f32 v[22:23], v[50:51], v[36:37], v[22:23] op_sel:[1,0,0] op_sel_hi:[1,1,1]
    v_lshlrev_b32 v48, 16, v14
    v_and_b32 v49, 0xffff0000, v14
    v_lshlrev_b32 v50, 16, v15
    v_and_b32 v51, 0xffff0000, v15
    v_pk_fma_f32 v[16:17], v[48:49], v[38:39], v[16:17] op_sel:[0,0,0] op_sel_hi:[0,1,1]
    v_pk_fma_f32 v[18:19], v[48:49], v[38:39], v[18:19] op_sel:[1,0,0] op_sel_hi:[1,1,1]
    v_pk_fma_f32 v[20:21], v[50:51], v[38:39], v[20:21] op_sel:[0,0,0] op_sel_hi:[0,1,1]
    v_pk_fma_f32 v[22:23], v[50:51], v[38:39], v[22:23] op_sel:[1,0,0] op_sel_hi:[1,1,1]
    v_lshlrev_b32 v48, 16, v64
    v_and_b32 v49, 0xffff0000, v64
    v_lshlrev_b32 v50, 16, v65
    v_and_b32 v51, 0xffff0000, v65
    v_pk_fma_f32 v[16:17], v[48:49], v[40:41], v[16:17] op_sel:[0,0,0] op_sel_hi:[0,1,1]
    v_pk_fma_f32 v[18:19], v[48:49], v[40:41], v[18:19] op_sel:[1,0,0] op_sel_hi:[1,1,1]
    v_pk_fma_f32 v[20:21], v[50:51], v[40:41], v[20:21] op_sel:[0,0,0] op_sel_hi:[0,1,1]
    v_pk_fma_f32 v[22:23], v[50:51], v[40:41], v[22:23] op_sel:[1,0,0] op_sel_hi:[1,1,1]
    v_lshlrev_b32 v48, 16, v66
    v_and_b32 v49, 0xffff0000, v66
    v_lshlrev_b32 v50, 16, v67
    v_and_b32 v51, 0xffff0000, v67
    v_pk_fma_f32 v[16:17], v[48:49], v[42:43], v[16:17] op_sel:[0,0,0] op_sel_hi:[0,1,1]
    v_pk_fma_f32 v[18:19], v[48:49], v[42:43], v[18:19] op_sel:[1,0,0] op_sel_hi:[1,1,1]
    v_pk_fma_f32 v[20:21], v[50:51], v[42:43], v[20:21] op_sel:[0,0,0] op_sel_hi:[0,1,1]
    v_pk_fma_f32 v[22:23], v[50:51], v[42:43], v[22:23] op_sel:[1,0,0] op_sel_hi:[1,1,1]
    v_lshlrev_b32 v48, 16, v68
    v_and_b32 v49, 0xffff0000, v68
    v_lshlrev_b32 v50, 16, v69
    v_and_b32 v51, 0xffff0000, v69
    v_pk_fma_f32 v[16:17], v[48:49], v[44:45], v[16:17] op_sel:[0,0,0] op_sel_hi:[0,1,1]
    v_pk_fma_f32 v[18:19], v[48:49], v[44:45], v[18:19] op_sel:[1,0,0] op_sel_hi:[1,1,1]
    v_pk_fma_f32 v[20:21], v[50:51], v[44:45], v[20:21] op_sel:[0,0,0] op_sel_hi:[0,1,1]
    v_pk_fma_f32 v[22:23], v[50:51], v[44:45], v[22:23] op_sel:[1,0,0] op_sel_hi:[1,1,1]
    v_lshlrev_b32 v48, 16, v70
    v_and_b32 v49, 0xffff0000, v70
    v_lshlrev_b32 v50, 16, v71
    v_and_b32 v51, 0xffff0000, v71
    v_pk_fma_f32 v[16:17], v[48:49], v[46:47], v[16:17] op_sel:[0,0,0] op_sel_hi:[0,1,1]
    v_pk_fma_f32 v[18:19], v[48:49], v[46:47], v[18:19] op_sel:[1,0,0] op_sel_hi:[1,1,1]
    v_pk_fma_f32 v[20:21], v[50:51], v[46:47], v[20:21] op_sel:[0,0,0] op_sel_hi:[0,1,1]
    v_pk_fma_f32 v[22:23], v[50:51], v[46:47], v[22:23] op_sel:[1,0,0] op_sel_hi:[1,1,1]
    v_mov_b32 v24, v16
    v_mov_b32 v25, v17
    v_mov_b32 v26, v18
    v_mov_b32 v27, v19
    v_mov_b32 v28, v20
    v_mov_b32 v29, v21
    v_mov_b32 v30, v22
    v_mov_b32 v31, v23
    s_nop 1
    v_permlane32_swap_b32 v16, v24
    v_permlane32_swap_b32 v17, v25
    v_permlane32_swap_b32 v18, v26
    v_permlane32_swap_b32 v19, v27
    v_permlane32_swap_b32 v20, v28
    v_permlane32_swap_b32 v21, v29
    v_permlane32_swap_b32 v22, v30
    v_permlane32_swap_b32 v23, v31
    v_add_f32 v16, v16, v24
    v_add_f32 v17, v17, v25
    v_add_f32 v18, v18, v26
    v_add_f32 v19, v19, v27
    v_add_f32 v20, v20, v28
    v_add_f32 v21, v21, v29
    v_add_f32 v22, v22, v30
    v_add_f32 v23, v23, v31
    v_cmp_le_u32 vcc, 32, v0
    s_nop 1
    v_cndmask_b32 v16, v16, v20, vcc
    v_cndmask_b32 v17, v17, v21, vcc
    v_cndmask_b32 v18, v18, v22, vcc
    v_cndmask_b32 v19, v19, v23, vcc
    v_cvt_pk_bf16_f32 v20, v16, v17
    v_cvt_pk_bf16_f32 v21, v18, v19
    v_and_b32 v4, 15, v0
    v_lshrrev_b32 v5, 4, v0
    v_lshlrev_b32 v6, 7, v4
    v_lshl_add_u32 v6, v5, 4, v6
    s_lshl_b32 s39, s64, 11
    s_add_u32 s39, s39, 983040
    buffer_load_dwordx4 v[32:35], v6, s[12:15], s39 offen
    buffer_load_dwordx4 v[36:39], v6, s[12:15], s39 offen offset:64
    v_lshrrev_b32 v3, 5, v0
    v_mul_u32_u24 v3, 288, v3
    v_add_u32 v3, v3, v2
    s_mul_i32 s39, s64, 576
    v_add_u32 v3, s39, v3
    ds_write_b32 v3, v20
    ds_write_b32 v3, v21 offset:144
    s_waitcnt lgkmcnt(0)
    s_barrier
    v_mul_u32_u24 v7, 144, v4
    v_lshl_add_u32 v7, v5, 4, v7
    ds_read_b128 v[40:43], v7
    ds_read_b128 v[44:47], v7 offset:64
    s_waitcnt vmcnt(0) lgkmcnt(0)
    v_mfma_f32_16x16x32_bf16 v[48:51], v[32:35], v[40:43], 0
    v_mfma_f32_16x16x32_bf16 v[48:51], v[36:39], v[44:47], v[48:51]
    v_lshlrev_b32 v6, 7, v4
    v_lshl_add_u32 v6, v5, 3, v6
    s_lshl_b32 s39, s65, 9
    s_lshl_b32 s38, s64, 5
    s_add_u32 s39, s39, s38
    s_nop 7
    s_nop 3
    v_cvt_pk_bf16_f32 v52, v48, v49
    v_cvt_pk_bf16_f32 v53, v50, v51
    buffer_store_dwordx2 v[52:53], v6, s[68:71], s39 offen
km_end:
    s_endpgm
.section .rodata,"a"
.p2align 6
.amdhsa_kernel k2s_kernel
  .amdhsa_next_free_vgpr 104
  .amdhsa_next_free_sgpr 96
  .amdhsa_accum_offset 104
  .amdhsa_group_segment_fixed_size 0
  .amdhsa_kernarg_size 88
  .amdhsa_user_sgpr_count 2
  .amdhsa_user_sgpr_kernarg_segment_ptr 1
  .amdhsa_system_sgpr_workgroup_id_x 1
.end_amdhsa_kernel
.p2align 6
.amdhsa_kernel k3b_kernel
  .amdhsa_next_free_vgpr 80
  .amdhsa_next_free_sgpr 96
  .amdhsa_accum_offset 80
  .amdhsa_group_segment_fixed_size 0
  .amdhsa_kernarg_size 88
  .amdhsa_user_sgpr_count 2
  .amdhsa_user_sgpr_kernarg_segment_ptr 1
  .amdhsa_system_sgpr_workgroup_id_x 1
.end_amdhsa_kernel
.p2align 6
.amdhsa_kernel k4m_kernel
  .amdhsa_next_free_vgpr 72
  .amdhsa_next_free_sgpr 100
  .amdhsa_accum_offset 72
  .amdhsa_group_segment_fixed_size 0
  .amdhsa_kernarg_size 88
  .amdhsa_user_sgpr_count 2
  .amdhsa_user_sgpr_kernarg_segment_ptr 1
  .amdhsa_system_sgpr_workgroup_id_x 1
.end_amdhsa_kernel
```
